```python
import torch

def _softmax(x, axis=-1):
    return torch.softmax(x, dim=axis)
def _gelu(x):
    return torch.nn.functional.gelu(x, approximate="tanh")
def _silu(x):
    return torch.nn.functional.silu(x)
def _sigmoid(x):
    return torch.sigmoid(x)
def _layernorm(x, axis=-1, eps=1e-5):
    m = x.mean(dim=axis, keepdim=True)
    v = x.var(dim=axis, keepdim=True, unbiased=False)
    return (x - m) / torch.sqrt(v + eps)
def _scatter_add(tgt, idx, src, axis=0):
    return tgt.clone().index_add_(axis, idx, src)
def _segment_sum(src, seg, n):
    out = torch.zeros((n,) + src.shape[1:], dtype=src.dtype)
    return out.index_add_(0, seg, src)
def _pad(x, pw):
    flat = tuple(v for pair in reversed(pw) for v in pair)
    return torch.nn.functional.pad(x, flat)

kernel_name = 'standalone__modern_conv_block_convnext__vision'

def setup_inputs():

    _w = (lambda a: (lambda t: t.to(torch.bfloat16) if t.is_floating_point() else t)(torch.as_tensor(a)))
    H = W = 512
    C = 96
    K = 1
    return {
        "x": _w((lambda *s: torch.randn(*s, dtype=torch.bfloat16) * 0.05)(1, H, W, C)),
        "dw": _w((lambda *s: torch.randn(*s, dtype=torch.bfloat16) * 0.1)(K, K, C)),
        "w1": _w((lambda *s: torch.randn(*s, dtype=torch.bfloat16) * 0.1)(C, 4 * C)),
        "b1": _w((lambda *s: torch.randn(*s, dtype=torch.bfloat16) * 0.4)(4 * C)),
        "w2": _w((lambda *s: torch.randn(*s, dtype=torch.bfloat16) * 0.05)(4 * C, C)),
        "b2": _w((lambda *s: torch.randn(*s, dtype=torch.bfloat16) * 0.4)(C)),
        "gamma": _w((lambda *s: torch.randn(*s, dtype=torch.bfloat16) * 0.05)(C)),
    }

def reference(x, dw, w1, b1, w2, b2, gamma):
    B, H, W, C = x.shape
    K = dw.shape[0]
    pad = K // 2
    xp = _pad(x, ((0,0),(pad,pad),(pad,pad),(0,0)))
    out = torch.zeros_like(x)
    for i in range(K):
        for j in range(K):
            out = out + xp[:, i:i+H, j:j+W, :] * dw[i, j][None, None, None, :]
    h = _layernorm(out, axis=-1)
    h = torch.einsum('bhwc,ce->bhwe', h, w1) + b1
    h = _gelu(h)
    h = torch.einsum('bhwe,ec->bhwc', h, w2) + b2
    return x + gamma[None, None, None, :] * h
```

```asm
; @launch grid=(256,1,1) block=(512,1,1) lds=156160
.amdgcn_target "amdgcn-amd-amdhsa--gfx950"
.text
.globl standalone__modern_conv_block_convnext__vision_kernel
.p2align 8
.type standalone__modern_conv_block_convnext__vision_kernel,@function
standalone__modern_conv_block_convnext__vision_kernel:
    s_cmp_ge_u32 s2, 256
    s_cbranch_scc1 L_end
    s_load_dwordx16 s[36:51], s[0:1], 0
    v_lshrrev_b32 v9, 6, v0
    v_mov_b32_e64 v10, v0
    v_and_b32 v0, 63, v0
    v_readfirstlane_b32 s24, v9
    v_lshrrev_b32 v156, 5, v0
    v_and_b32 v157, 31, v0
    v_mul_u32_u24 v7, 192, v157
    v_lshl_add_u32 v7, v156, 4, v7
    v_lshlrev_b32 v164, 1, v10
    v_lshlrev_b32 v166, 2, v0
    v_lshlrev_b32 v170, 4, v156
    s_lshl_b32 s27, s2, 3
    s_add_u32 s27, s27, s24
    s_mul_i32 s27, s27, 6144
    s_lshl_b32 s68, s24, 5
    s_min_u32 s68, s68, 160
    s_and_b32 s16, s24, 3
    s_cmp_ge_u32 s24, 4
    s_cselect_b32 s17, 86, 43
    s_cselect_b32 s18, 3, 6
    s_cselect_b32 s19, 3072, 64
    s_cselect_b32 s20, 64, 12288
    s_cselect_b32 s21, 3, 12
    s_cselect_b32 s22, 0x60, 1
    s_cselect_b32 s23, 73728, 0
    s_lshl_b32 s21, s21, 6
    s_lshl_b32 s22, s22, 7
    s_lshl_b32 s73, s16, 10
    s_add_u32 s23, s23, s73
    v_lshrrev_b32 v180, 2, v0
    v_and_b32 v181, 3, v0
    v_mul_lo_u32 v20, v180, s21
    v_lshl_add_u32 v20, v181, 4, v20
    s_add_u32 s73, s16, 0
    s_mul_i32 s74, s73, s17
    s_lshr_b32 s74, s74, 8
    s_mul_i32 s75, s74, s18
    s_sub_u32 s75, s73, s75
    s_mul_i32 s74, s74, s19
    s_mul_i32 s75, s75, s20
    s_add_u32 s70, s74, s75
    s_add_u32 s73, s16, 4
    s_mul_i32 s74, s73, s17
    s_lshr_b32 s74, s74, 8
    s_mul_i32 s75, s74, s18
    s_sub_u32 s75, s73, s75
    s_mul_i32 s74, s74, s19
    s_mul_i32 s75, s75, s20
    s_add_u32 s71, s74, s75
    s_add_u32 s73, s16, 8
    s_mul_i32 s74, s73, s17
    s_lshr_b32 s74, s74, 8
    s_mul_i32 s75, s74, s18
    s_sub_u32 s75, s73, s75
    s_mul_i32 s74, s74, s19
    s_mul_i32 s75, s75, s20
    s_add_u32 s72, s74, s75
    s_lshr_b32 s25, s2, 3
    s_and_b32 s25, s25, 31
    s_mul_i32 s73, s25, 57
    s_lshr_b32 s73, s73, 10
    s_mul_i32 s73, s73, 18
    s_sub_u32 s25, s25, s73
    s_lshl_b32 s25, s25, 12
    v_lshlrev_b32 v197, 6, v0
    s_waitcnt lgkmcnt(0)
    s_cmp_ge_u32 s24, 4
    s_cselect_b32 s12, s44, s40
    s_cselect_b32 s13, s45, s41
    s_and_b32 s13, s13, 0xffff
    s_mov_b32 s15, 0x20000
    s_mov_b32 s56, s42
    s_and_b32 s57, s43, 0xffff
    s_mov_b32 s58, 768
    s_mov_b32 s59, 0x20000
    s_mov_b32 s52, s38
    s_and_b32 s53, s39, 0xffff
    s_mov_b32 s54, 192
    s_mov_b32 s55, 0x20000
    s_cmp_ge_u32 s24, 6
    s_cbranch_scc1 L_pl67
    buffer_load_ushort v165, v164, s[56:59], 0 offen
    buffer_load_dwordx4 v[172:175], v170, s[52:55], s68 offen
    s_branch L_pld
L_pl67:
    s_mov_b32 s64, s48
    s_and_b32 s65, s49, 0xffff
    s_mov_b32 s66, 192
    s_mov_b32 s67, 0x20000
    s_mov_b32 s60, s46
    s_and_b32 s61, s47, 0xffff
    s_mov_b32 s62, 192
    s_mov_b32 s63, 0x20000
    s_cmp_eq_u32 s24, 7
    s_cbranch_scc1 L_pl7
    buffer_load_dword v167, v166, s[64:67], 0 offen
    buffer_load_dword v168, v166, s[60:63], 0 offen
    s_branch L_pld
L_pl7:
    buffer_load_dword v169, v166, s[52:55], 0 offen
L_pld:
    s_mov_b32 s4, s36
    s_and_b32 s5, s37, 0xffff
    s_mov_b32 s6, 50331648
    s_mov_b32 s7, 0x20000
    s_mul_i32 s69, s24, 6144
    s_add_u32 s69, s69, 98304
    v_lshlrev_b32 v198, 4, v0
    s_add_u32 m0, s69, 0
    s_add_u32 s75, s27, 0
    buffer_load_dwordx4 v198, s[4:7], s75 offen nt lds
    s_add_u32 m0, s69, 1024
    s_add_u32 s75, s27, 1024
    buffer_load_dwordx4 v198, s[4:7], s75 offen nt lds
    s_add_u32 m0, s69, 2048
    s_add_u32 s75, s27, 2048
    buffer_load_dwordx4 v198, s[4:7], s75 offen nt lds
    s_add_u32 m0, s69, 3072
    s_add_u32 s75, s27, 3072
    buffer_load_dwordx4 v198, s[4:7], s75 offen nt lds
    s_add_u32 m0, s69, 4096
    s_add_u32 s75, s27, 4096
    buffer_load_dwordx4 v198, s[4:7], s75 offen nt lds
    s_add_u32 m0, s69, 5120
    s_add_u32 s75, s27, 5120
    buffer_load_dwordx4 v198, s[4:7], s75 offen nt lds
    s_mov_b32 s14, 73728
    s_cmp_lg_u32 s16, 0
    s_cbranch_scc1 L_nopf0
    buffer_load_dword v196, v197, s[12:15], s25 offen
L_nopf0:
    s_mov_b32 s8, s50
    s_and_b32 s9, s51, 0xffff
    s_mov_b32 s10, 0
    s_mov_b32 s11, 0x20000
    s_mov_b32 s30, 0xc09d30fc
    s_mov_b32 s31, 0xbc2aaaab
    s_mov_b32 s32, 0x3d423f85
    s_mov_b32 s34, 0x3eeff558
    s_mov_b32 s35, 0x40088e99
    v_mov_b32 v11, 0x383ef424
    v_lshlrev_b32 v5, 4, v156
    v_add_u32 v5, 147456, v5
    v_lshlrev_b32 v6, 4, v0
    v_add_u32 v6, 150016, v6
    v_bfe_u32 v188, v0, 4, 1
    v_bfe_u32 v189, v0, 2, 2
    v_and_b32 v190, 3, v0
    v_lshlrev_b32 v191, 6, v189
    v_lshl_add_u32 v191, v188, 5, v191
    v_lshl_add_u32 v1, v190, 3, v191
    v_lshl_add_u32 v1, v156, 9, v1
    v_add_u32 v2, 36864, v1
    v_and_b32 v192, 1, v0
    v_bfe_u32 v193, v0, 1, 1
    v_lshl_add_u32 v191, v192, 4, v191
    v_lshl_add_u32 v191, v193, 3, v191
    v_lshl_add_u32 v3, v156, 8, v191
    v_add_u32 v3, 73728, v3
    v_add_u32 v4, 36864, v3
    v_bfe_u32 v204, v0, 2, 1
    v_and_b32 v205, 1, v0
    v_mov_b32 v206, 0xffff
    v_mov_b32 v207, 0xffff0000
    v_cmp_eq_u32 vcc, 1, v205
    s_nop 1
    v_cndmask_b32 v206, v206, v207, vcc
    v_cmp_eq_u32 vcc, v204, v156
    s_nop 1
    v_cndmask_b32 v206, 0, v206, vcc
    v_bfe_u32 v207, v0, 4, 1
    v_bfe_u32 v208, v0, 3, 1
    v_bfe_u32 v209, v0, 1, 1
    v_lshlrev_b32 v207, 2, v207
    v_lshl_add_u32 v207, v208, 1, v207
    v_add_u32 v207, v207, v209
    v_cmp_eq_u32 vcc, 0, v207
    s_nop 1
    v_cndmask_b32 v212, 0, v206, vcc
    v_cmp_eq_u32 vcc, 1, v207
    s_nop 1
    v_cndmask_b32 v213, 0, v206, vcc
    v_cmp_eq_u32 vcc, 2, v207
    s_nop 1
    v_cndmask_b32 v214, 0, v206, vcc
    v_cmp_eq_u32 vcc, 3, v207
    s_nop 1
    v_cndmask_b32 v215, 0, v206, vcc
    v_cmp_eq_u32 vcc, 4, v207
    s_nop 1
    v_cndmask_b32 v216, 0, v206, vcc
    v_cmp_eq_u32 vcc, 5, v207
    s_nop 1
    v_cndmask_b32 v217, 0, v206, vcc
    v_cmp_eq_u32 vcc, 6, v207
    s_nop 1
    v_cndmask_b32 v218, 0, v206, vcc
    v_cmp_eq_u32 vcc, 7, v207
    s_nop 1
    v_cndmask_b32 v219, 0, v206, vcc
    v_and_b32 v12, 0x3f803f80, v212
    v_and_b32 v13, 0x3f803f80, v213
    v_and_b32 v14, 0x3f803f80, v214
    v_and_b32 v15, 0x3f803f80, v215
    v_and_b32 v16, 0x3f803f80, v216
    v_and_b32 v17, 0x3f803f80, v217
    v_and_b32 v18, 0x3f803f80, v218
    v_and_b32 v19, 0x3f803f80, v219
    s_add_u32 m0, s23, 0
    s_nop 0
    buffer_load_dwordx4 v20, s[12:15], s70 offen lds
    s_add_u32 m0, s23, 4096
    s_nop 0
    buffer_load_dwordx4 v20, s[12:15], s71 offen lds
    s_add_u32 m0, s23, 8192
    s_nop 0
    buffer_load_dwordx4 v20, s[12:15], s72 offen lds
    v_add_u32 v20, s22, v20
    s_waitcnt vmcnt(9)
    s_cmp_ge_u32 s24, 6
    s_cbranch_scc1 L_p67
    v_lshlrev_b32 v165, 16, v165
    v_mul_f32_e64 v165, s34, v165
    v_lshlrev_b32 v164, 2, v10
    v_add_u32 v164, 147456, v164
    ds_write_b32 v164, v165
    s_bitcmp1_b32 s24, 0
    s_cbranch_scc0 L_kl0
    v_mov_b32 v212, v216
    v_mov_b32 v213, v217
    v_mov_b32 v214, v218
    v_mov_b32 v215, v219
L_kl0:
    v_and_b32 v172, v172, v212
    v_and_b32 v173, v173, v213
    v_and_b32 v174, v174, v214
    v_and_b32 v175, v175, v215
    s_lshl_b32 s68, s24, 10
    v_add_u32 v164, s68, v6
    ds_write_b128 v164, v[172:175]
    s_branch L_pdone
L_p67:
    v_cmp_gt_u32 vcc, 48, v0
    s_nop 3
    s_and_saveexec_b64 s[74:75], vcc
    s_cmp_eq_u32 s24, 7
    s_cbranch_scc1 L_p7
    v_lshlrev_b32 v172, 16, v167
    v_and_b32 v173, 0xffff0000, v167
    v_lshlrev_b32 v174, 16, v168
    v_and_b32 v175, 0xffff0000, v168
    v_mul_f32 v174, v172, v174
    v_mul_f32 v175, v173, v175
    v_mul_f32_e64 v172, s35, v172
    v_mul_f32 v173, s35, v173
    v_lshrrev_b32 v164, 4, v0
    v_lshlrev_b32 v164, 7, v164
    v_bfe_u32 v165, v0, 3, 1
    v_lshl_add_u32 v164, v165, 6, v164
    v_bfe_u32 v165, v0, 1, 1
    v_lshl_add_u32 v164, v165, 5, v164
    v_bfe_u32 v165, v0, 2, 1
    v_lshl_add_u32 v164, v165, 4, v164
    v_and_b32 v165, 1, v0
    v_lshl_add_u32 v164, v165, 3, v164
    v_add_u32 v164, 147456, v164
    ds_write_b64 v164, v[172:173] offset:1536
    ds_write_b64 v164, v[174:175] offset:1920
    s_branch L_p67e
L_p7:
    v_add_u32 v164, 149760, v166
    ds_write_b32 v164, v169
L_p67e:
    s_mov_b64 exec, s[74:75]
L_pdone:
    v_and_b32 v10, 1, v0
    v_mul_u32_u24 v10, 160, v10
    v_sub_u32 v10, v7, v10
    s_mov_b32 s54, 0x55555555
    s_mov_b32 s55, 0x55555555
    v_add_u32 v198, s69, v7
    s_waitcnt vmcnt(3)
    ds_read_b128 v[84:87], v198 offset:0
    ds_read_b128 v[88:91], v198 offset:32
    ds_read_b128 v[92:95], v198 offset:64
    ds_read_b128 v[96:99], v198 offset:96
    ds_read_b128 v[100:103], v198 offset:128
    ds_read_b128 v[104:107], v198 offset:160
    s_waitcnt vmcnt(3) lgkmcnt(0)
    s_barrier
    s_mov_b32 s26, 4
    s_cmp_ge_u32 s24, 4
    s_cbranch_scc1 L_roleB
    s_setprio 0
    ds_read_b128 v[232:235], v5 offset:2304
    ds_read_b128 v[236:239], v5 offset:2336
    ds_read_b128 v[240:243], v5 offset:2368
    ds_read_b128 v[244:247], v5 offset:2400
    ds_read_b128 v[248:251], v5 offset:2432
    ds_read_b128 v[252:255], v5 offset:2464
    s_add_u32 m0, s23, 12288
    s_nop 0
    buffer_load_dwordx4 v20, s[12:15], s70 offen lds
    s_add_u32 m0, s23, 16384
    s_nop 0
    buffer_load_dwordx4 v20, s[12:15], s71 offen lds
    s_add_u32 m0, s23, 20480
    s_nop 0
    buffer_load_dwordx4 v20, s[12:15], s72 offen lds
    v_add_u32 v20, s22, v20
    s_add_u32 m0, s23, 24576
    s_nop 0
    buffer_load_dwordx4 v20, s[12:15], s70 offen lds
    s_add_u32 m0, s23, 28672
    s_nop 0
    buffer_load_dwordx4 v20, s[12:15], s71 offen lds
    s_add_u32 m0, s23, 32768
    s_nop 0
    buffer_load_dwordx4 v20, s[12:15], s72 offen lds
    v_add_u32 v20, s22, v20
    s_mov_b32 s29, s27
    s_add_u32 s27, s27, 12582912
    s_cmp_eq_u32 s26, 1
    s_cselect_b32 s6, 0, 50331648
    s_waitcnt lgkmcnt(5)
    v_dot2_f32_bf16 v228, v84, v232, 0
    v_dot2_f32_bf16 v229, v85, v233, 0
    v_dot2_f32_bf16 v230, v86, v234, 0
    v_dot2_f32_bf16 v231, v87, v235, 0
    ds_read_b128 v[232:235], v6 offset:0
    s_waitcnt lgkmcnt(5)
    v_dot2_f32_bf16 v228, v88, v236, v228
    v_dot2_f32_bf16 v229, v89, v237, v229
    v_dot2_f32_bf16 v230, v90, v238, v230
    v_dot2_f32_bf16 v231, v91, v239, v231
    ds_read_b128 v[236:239], v6 offset:1024
    s_waitcnt lgkmcnt(5)
    v_dot2_f32_bf16 v228, v92, v240, v228
    v_dot2_f32_bf16 v229, v93, v241, v229
    v_dot2_f32_bf16 v230, v94, v242, v230
    v_dot2_f32_bf16 v231, v95, v243, v231
    ds_read_b128 v[240:243], v6 offset:2048
    s_waitcnt lgkmcnt(5)
    v_dot2_f32_bf16 v228, v96, v244, v228
    v_dot2_f32_bf16 v229, v97, v245, v229
    v_dot2_f32_bf16 v230, v98, v246, v230
    v_dot2_f32_bf16 v231, v99, v247, v231
    ds_read_b128 v[244:247], v6 offset:3072
    s_waitcnt lgkmcnt(5)
    v_dot2_f32_bf16 v228, v100, v248, v228
    v_dot2_f32_bf16 v229, v101, v249, v229
    v_dot2_f32_bf16 v230, v102, v250, v230
    v_dot2_f32_bf16 v231, v103, v251, v231
    ds_read_b128 v[248:251], v6 offset:4096
    s_waitcnt lgkmcnt(5)
    v_dot2_f32_bf16 v228, v104, v252, v228
    v_dot2_f32_bf16 v229, v105, v253, v229
    v_dot2_f32_bf16 v230, v106, v254, v230
    v_dot2_f32_bf16 v231, v107, v255, v231
    ds_read_b128 v[252:255], v6 offset:5120
    v_add_f32 v228, v228, v229
    v_add_f32 v230, v230, v231
    v_add_f32 v228, v228, v230
    v_mov_b32 v9, v228
    s_nop 1
    v_permlane32_swap_b32 v9, v228
    v_add_f32 v228, v228, v9
    v_mul_f32 v204, s31, v228
    v_mul_f32 v205, s31, v228
    v_mul_f32 v206, s31, v228
    v_mul_f32 v207, s31, v228
    v_mul_f32 v208, s31, v228
    v_mul_f32 v209, s31, v228
    v_mul_f32 v210, s31, v228
    v_mul_f32 v211, s31, v228
    v_mul_f32 v212, s31, v228
    v_mul_f32 v213, s31, v228
    v_mul_f32 v214, s31, v228
    v_mul_f32 v215, s31, v228
    v_mul_f32 v216, s31, v228
    v_mul_f32 v217, s31, v228
    v_mul_f32 v218, s31, v228
    v_mul_f32 v219, s31, v228
    s_waitcnt lgkmcnt(5)
    s_nop 0
    v_mfma_f32_32x32x16_bf16 v[156:171], v[232:235], v[84:87], v[204:219]
    s_waitcnt lgkmcnt(3)
    v_mfma_f32_32x32x16_bf16 v[172:187], v[240:243], v[92:95], v[204:219]
    s_waitcnt lgkmcnt(1)
    v_mfma_f32_32x32x16_bf16 v[188:203], v[248:251], v[100:103], v[204:219]
    v_mfma_f32_32x32x16_bf16 v[156:171], v[236:239], v[88:91], v[156:171]
    v_mfma_f32_32x32x16_bf16 v[172:187], v[244:247], v[96:99], v[172:187]
    s_waitcnt lgkmcnt(0)
    v_mfma_f32_32x32x16_bf16 v[188:203], v[252:255], v[104:107], v[188:203]
    s_waitcnt vmcnt(6)
    s_barrier
    ds_read_b64_tr_b16 v[232:233], v1 offset:0
    ds_read_b64_tr_b16 v[234:235], v1 offset:256
    ds_read_b64_tr_b16 v[236:237], v1 offset:1024
    ds_read_b64_tr_b16 v[238:239], v1 offset:1280
    ds_read_b64_tr_b16 v[240:241], v1 offset:2048
    ds_read_b64_tr_b16 v[242:243], v1 offset:2304
    s_nop 0
    v_mul_f32 v228, v156, v156
    v_mul_f32 v229, v157, v157
    v_mul_f32 v230, v158, v158
    v_mul_f32_e64 v231, v159, v159
    v_fma_f32 v228, v160, v160, v228
    v_fma_f32 v229, v161, v161, v229
    v_fma_f32 v230, v162, v162, v230
    v_fma_f32 v231, v163, v163, v231
    v_fma_f32 v228, v164, v164, v228
    v_fma_f32 v229, v165, v165, v229
    v_fma_f32 v230, v166, v166, v230
    v_fma_f32 v231, v167, v167, v231
    v_fma_f32 v228, v168, v168, v228
    v_fma_f32 v229, v169, v169, v229
    v_fma_f32 v230, v170, v170, v230
    v_fma_f32 v231, v171, v171, v231
    v_fma_f32 v228, v172, v172, v228
    v_fma_f32 v229, v173, v173, v229
    v_fma_f32 v230, v174, v174, v230
    v_fma_f32 v231, v175, v175, v231
    v_fma_f32 v228, v176, v176, v228
    v_fma_f32 v229, v177, v177, v229
    v_fma_f32 v230, v178, v178, v230
    v_fma_f32 v231, v179, v179, v231
    v_fma_f32 v228, v180, v180, v228
    v_fma_f32 v229, v181, v181, v229
    v_fma_f32 v230, v182, v182, v230
    v_fma_f32 v231, v183, v183, v231
    v_fma_f32 v228, v184, v184, v228
    v_fma_f32 v229, v185, v185, v229
    v_fma_f32 v230, v186, v186, v230
    v_fma_f32 v231, v187, v187, v231
    v_fma_f32 v228, v188, v188, v228
    v_fma_f32 v229, v189, v189, v229
    v_fma_f32 v230, v190, v190, v230
    v_fma_f32 v231, v191, v191, v231
    v_fma_f32 v228, v192, v192, v228
    v_fma_f32 v229, v193, v193, v229
    v_fma_f32 v230, v194, v194, v230
    v_fma_f32 v231, v195, v195, v231
    v_fma_f32 v228, v196, v196, v228
    v_fma_f32 v229, v197, v197, v229
    v_fma_f32 v230, v198, v198, v230
    v_fma_f32 v231, v199, v199, v231
    v_fma_f32 v228, v200, v200, v228
    v_fma_f32 v229, v201, v201, v229
    v_fma_f32 v230, v202, v202, v230
    v_fma_f32 v231, v203, v203, v231
    v_add_f32 v228, v228, v229
    v_add_f32 v230, v230, v231
    v_add_f32 v228, v228, v230
    v_mov_b32 v9, v228
    s_nop 1
    v_permlane32_swap_b32 v9, v228
    v_add_f32_e64 v228, v228, v9
    v_fma_f32 v228, v228, s32, v11
    v_rsq_f32 v8, v228
    s_nop 0
    v_mul_f32 v156, v8, v156
    v_mul_f32 v157, v8, v157
    v_mul_f32 v158, v8, v158
    v_mul_f32 v159, v8, v159
    v_mul_f32 v160, v8, v160
    v_mul_f32 v161, v8, v161
    v_mul_f32 v162, v8, v162
    v_mul_f32 v163, v8, v163
    v_mul_f32 v164, v8, v164
    v_mul_f32 v165, v8, v165
    v_mul_f32 v166, v8, v166
    v_mul_f32 v167, v8, v167
    v_mul_f32 v168, v8, v168
    v_mul_f32 v169, v8, v169
    v_mul_f32 v170, v8, v170
    v_mul_f32 v171, v8, v171
    v_cvt_pk_bf16_f32 v36, v156, v157
    v_cvt_pk_bf16_f32 v37, v158, v159
    v_cvt_pk_bf16_f32 v38, v160, v161
    v_cvt_pk_bf16_f32 v39, v162, v163
    v_cvt_pk_bf16_f32 v40, v164, v165
    v_cvt_pk_bf16_f32 v41, v166, v167
    v_cvt_pk_bf16_f32 v42, v168, v169
    v_cvt_pk_bf16_f32 v43, v170, v171
    ds_read_b128 v[156:159], v5 offset:0
    ds_read_b128 v[160:163], v5 offset:32
    ds_read_b128 v[164:167], v5 offset:64
    ds_read_b128 v[168:171], v5 offset:96
    v_mul_f32 v172, v8, v172
    v_mul_f32 v173, v8, v173
    v_mul_f32 v174, v8, v174
    v_mul_f32 v175, v8, v175
    v_mul_f32 v176, v8, v176
    v_mul_f32 v177, v8, v177
    v_mul_f32 v178, v8, v178
    v_mul_f32 v179, v8, v179
    v_mul_f32 v180, v8, v180
    v_mul_f32 v181, v8, v181
    v_mul_f32 v182, v8, v182
    v_mul_f32 v183, v8, v183
    v_mul_f32 v184, v8, v184
    v_mul_f32 v185, v8, v185
    v_mul_f32 v186, v8, v186
    v_mul_f32 v187, v8, v187
    v_cvt_pk_bf16_f32 v44, v172, v173
    v_cvt_pk_bf16_f32 v45, v174, v175
    v_cvt_pk_bf16_f32 v46, v176, v177
    v_cvt_pk_bf16_f32 v47, v178, v179
    v_cvt_pk_bf16_f32 v48, v180, v181
    v_cvt_pk_bf16_f32 v49, v182, v183
    v_cvt_pk_bf16_f32 v50, v184, v185
    v_cvt_pk_bf16_f32 v51, v186, v187
    v_mul_f32 v188, v8, v188
    v_mul_f32 v189, v8, v189
    v_mul_f32 v190, v8, v190
    v_mul_f32 v191, v8, v191
    v_mul_f32 v192, v8, v192
    v_mul_f32 v193, v8, v193
    v_mul_f32 v194, v8, v194
    v_mul_f32 v195, v8, v195
    v_mul_f32 v196, v8, v196
    v_mul_f32 v197, v8, v197
    v_mul_f32 v198, v8, v198
    v_mul_f32 v199, v8, v199
    v_mul_f32 v200, v8, v200
    v_mul_f32 v201, v8, v201
    v_mul_f32 v202, v8, v202
    v_mul_f32 v203, v8, v203
    v_cvt_pk_bf16_f32 v52, v188, v189
    v_cvt_pk_bf16_f32 v53, v190, v191
    v_cvt_pk_bf16_f32 v54, v192, v193
    v_cvt_pk_bf16_f32 v55, v194, v195
    v_cvt_pk_bf16_f32 v56, v196, v197
    v_cvt_pk_bf16_f32 v57, v198, v199
    v_cvt_pk_bf16_f32 v58, v200, v201
    v_cvt_pk_bf16_f32 v59, v202, v203
    s_waitcnt lgkmcnt(0)
    v_mfma_f32_32x32x16_bf16 v[156:171], v[232:235], v[36:39], v[156:171]
    ds_read_b64_tr_b16 v[232:233], v1 offset:3072
    ds_read_b64_tr_b16 v[234:235], v1 offset:3328
    v_mfma_f32_32x32x16_bf16 v[156:171], v[236:239], v[40:43], v[156:171]
    ds_read_b64_tr_b16 v[236:237], v1 offset:4096
    ds_read_b64_tr_b16 v[238:239], v1 offset:4352
    v_mfma_f32_32x32x16_bf16 v[156:171], v[240:243], v[44:47], v[156:171]
    ds_read_b64_tr_b16 v[240:241], v1 offset:5120
    ds_read_b64_tr_b16 v[242:243], v1 offset:5376
    s_waitcnt lgkmcnt(4)
    v_mfma_f32_32x32x16_bf16 v[156:171], v[232:235], v[48:51], v[156:171]
    ds_read_b64_tr_b16 v[232:233], v1 offset:6144
    ds_read_b64_tr_b16 v[234:235], v1 offset:6400
    s_waitcnt lgkmcnt(4)
    v_mfma_f32_32x32x16_bf16 v[156:171], v[236:239], v[52:55], v[156:171]
    ds_read_b64_tr_b16 v[236:237], v1 offset:7168
    ds_read_b64_tr_b16 v[238:239], v1 offset:7424
    s_waitcnt lgkmcnt(4)
    v_mfma_f32_32x32x16_bf16 v[156:171], v[240:243], v[56:59], v[156:171]
    ds_read_b64_tr_b16 v[240:241], v1 offset:8192
    ds_read_b64_tr_b16 v[242:243], v1 offset:8448
    ds_read_b128 v[172:175], v5 offset:128
    ds_read_b128 v[176:179], v5 offset:160
    ds_read_b128 v[180:183], v5 offset:192
    ds_read_b128 v[184:187], v5 offset:224
    s_nop 7
    s_branch L_stepsA
.p2align 6
L_loopA:
    s_waitcnt vmcnt(0) lgkmcnt(0)
    s_setprio 0
    ds_read_b128 v[244:247], v5 offset:2400
    ds_read_b128 v[248:251], v5 offset:2432
    ds_read_b128 v[252:255], v5 offset:2464
    ds_read_b128 v[20:23], v5 offset:1920
    ds_read_b128 v[24:27], v5 offset:1952
    ds_read_b128 v[28:31], v5 offset:1984
    ds_read_b128 v[32:35], v5 offset:2016
    s_mov_b32 s29, s27
    s_add_u32 s27, s27, 12582912
    s_cmp_eq_u32 s26, 1
    s_cselect_b32 s6, 0, 50331648
    v_dot2_f32_bf16 v228, v84, v232, 0
    v_dot2_f32_bf16 v229, v85, v233, 0
    v_dot2_f32_bf16 v230, v86, v234, 0
    v_dot2_f32_bf16 v231, v87, v235, 0
    ds_read_b128 v[232:235], v6 offset:0
    v_dot2_f32_bf16 v228, v88, v236, v228
    v_dot2_f32_bf16 v229, v89, v237, v229
    v_dot2_f32_bf16 v230, v90, v238, v230
    v_dot2_f32_bf16 v231, v91, v239, v231
    ds_read_b128 v[236:239], v6 offset:1024
    v_dot2_f32_bf16 v228, v92, v240, v228
    v_dot2_f32_bf16 v229, v93, v241, v229
    v_dot2_f32_bf16 v230, v94, v242, v230
    v_dot2_f32_bf16 v231, v95, v243, v231
    ds_read_b128 v[240:243], v6 offset:2048
    s_waitcnt lgkmcnt(9)
    v_dot2_f32_bf16 v228, v96, v244, v228
    v_dot2_f32_bf16 v229, v97, v245, v229
    v_dot2_f32_bf16 v230, v98, v246, v230
    v_dot2_f32_bf16 v231, v99, v247, v231
    ds_read_b128 v[244:247], v6 offset:3072
    s_waitcnt lgkmcnt(9)
    v_dot2_f32_bf16 v228, v100, v248, v228
    v_dot2_f32_bf16 v229, v101, v249, v229
    v_dot2_f32_bf16 v230, v102, v250, v230
    v_dot2_f32_bf16 v231, v103, v251, v231
    ds_read_b128 v[248:251], v6 offset:4096
    s_waitcnt lgkmcnt(9)
    v_dot2_f32_bf16 v228, v104, v252, v228
    v_dot2_f32_bf16 v229, v105, v253, v229
    v_dot2_f32_bf16 v230, v106, v254, v230
    v_dot2_f32_bf16 v231, v107, v255, v231
    ds_read_b128 v[252:255], v6 offset:5120
    s_waitcnt lgkmcnt(6)
    v_mfma_f32_32x32x16_bf16 v[20:35], v[12:15], v[60:63], v[20:35]
    v_mfma_f32_32x32x16_bf16 v[20:35], v[16:19], v[64:67], v[20:35]
    ds_read_b128 v[36:39], v5 offset:1536
    ds_read_b128 v[40:43], v5 offset:1568
    ds_read_b128 v[44:47], v5 offset:1600
    ds_read_b128 v[48:51], v5 offset:1632
    v_add_f32 v228, v228, v229
    v_add_f32 v230, v230, v231
    v_add_f32 v228, v228, v230
    v_mov_b32 v9, v228
    s_nop 1
    v_permlane32_swap_b32 v9, v228
    v_add_f32 v228, v228, v9
    v_mul_f32 v204, s31, v228
    v_mul_f32 v205, s31, v228
    v_mul_f32 v206, s31, v228
    v_mul_f32 v207, s31, v228
    v_mul_f32 v208, s31, v228
    v_mul_f32 v209, s31, v228
    v_mul_f32 v210, s31, v228
    v_mul_f32 v211, s31, v228
    v_mul_f32 v212, s31, v228
    v_mul_f32 v213, s31, v228
    v_mul_f32 v214, s31, v228
    v_mul_f32 v215, s31, v228
    v_mul_f32 v216, s31, v228
    v_mul_f32 v217, s31, v228
    v_mul_f32 v218, s31, v228
    v_mul_f32 v219, s31, v228
    s_waitcnt lgkmcnt(9)
    s_nop 0
    v_mfma_f32_32x32x16_bf16 v[156:171], v[232:235], v[84:87], v[204:219]
    s_waitcnt lgkmcnt(7)
    v_mfma_f32_32x32x16_bf16 v[172:187], v[240:243], v[92:95], v[204:219]
    s_waitcnt lgkmcnt(5)
    v_mfma_f32_32x32x16_bf16 v[188:203], v[248:251], v[100:103], v[204:219]
    v_mfma_f32_32x32x16_bf16 v[156:171], v[236:239], v[88:91], v[156:171]
    v_mfma_f32_32x32x16_bf16 v[172:187], v[244:247], v[96:99], v[172:187]
    s_waitcnt lgkmcnt(4)
    v_mfma_f32_32x32x16_bf16 v[188:203], v[252:255], v[104:107], v[188:203]
    s_waitcnt lgkmcnt(3)
    v_fma_f32 v108, v108, v36, v20
    v_fma_f32 v109, v109, v37, v21
    v_fma_f32 v110, v110, v38, v22
    v_fma_f32 v111, v111, v39, v23
    s_waitcnt lgkmcnt(2)
    v_fma_f32 v112, v112, v40, v24
    v_fma_f32 v113, v113, v41, v25
    v_fma_f32 v114, v114, v42, v26
    v_fma_f32 v115, v115, v43, v27
    s_waitcnt lgkmcnt(1)
    v_fma_f32 v116, v116, v44, v28
    v_fma_f32 v117, v117, v45, v29
    v_fma_f32 v118, v118, v46, v30
    v_fma_f32 v119, v119, v47, v31
    s_waitcnt lgkmcnt(0)
    v_fma_f32 v120, v120, v48, v32
    v_fma_f32 v121, v121, v49, v33
    v_fma_f32 v122, v122, v50, v34
    v_fma_f32 v123, v123, v51, v35
    ds_read_b128 v[20:23], v5 offset:2048
    ds_read_b128 v[24:27], v5 offset:2080
    ds_read_b128 v[28:31], v5 offset:2112
    ds_read_b128 v[32:35], v5 offset:2144
    ds_read_b128 v[36:39], v5 offset:1664
    ds_read_b128 v[40:43], v5 offset:1696
    ds_read_b128 v[44:47], v5 offset:1728
    ds_read_b128 v[48:51], v5 offset:1760
    v_cvt_pk_bf16_f32 v108, v108, v109
    v_cvt_pk_bf16_f32 v109, v110, v111
    v_cvt_pk_bf16_f32 v110, v112, v113
    v_cvt_pk_bf16_f32 v111, v114, v115
    v_cvt_pk_bf16_f32 v112, v116, v117
    v_cvt_pk_bf16_f32 v113, v118, v119
    v_cvt_pk_bf16_f32 v114, v120, v121
    v_cvt_pk_bf16_f32 v115, v122, v123
    s_mov_b64 vcc, s[54:55]
    v_cndmask_b32_dpp v60, v112, v108, vcc quad_perm:[1,0,3,2] row_mask:0xf bank_mask:0xf
    v_cndmask_b32_dpp v61, v113, v109, vcc quad_perm:[1,0,3,2] row_mask:0xf bank_mask:0xf
    v_cndmask_b32_dpp v62, v114, v110, vcc quad_perm:[1,0,3,2] row_mask:0xf bank_mask:0xf
    v_cndmask_b32_dpp v63, v115, v111, vcc quad_perm:[1,0,3,2] row_mask:0xf bank_mask:0xf
    s_not_b64 vcc, vcc
    v_cndmask_b32_dpp v64, v108, v112, vcc quad_perm:[1,0,3,2] row_mask:0xf bank_mask:0xf
    v_cndmask_b32_dpp v65, v109, v113, vcc quad_perm:[1,0,3,2] row_mask:0xf bank_mask:0xf
    v_cndmask_b32_dpp v66, v110, v114, vcc quad_perm:[1,0,3,2] row_mask:0xf bank_mask:0xf
    v_cndmask_b32_dpp v67, v111, v115, vcc quad_perm:[1,0,3,2] row_mask:0xf bank_mask:0xf
    s_waitcnt lgkmcnt(4)
    v_mfma_f32_32x32x16_bf16 v[20:35], v[12:15], v[68:71], v[20:35]
    v_mfma_f32_32x32x16_bf16 v[20:35], v[16:19], v[72:75], v[20:35]
    ds_read_b64_tr_b16 v[232:233], v1 offset:0
    ds_read_b64_tr_b16 v[234:235], v1 offset:256
    ds_read_b64_tr_b16 v[236:237], v1 offset:1024
    ds_read_b64_tr_b16 v[238:239], v1 offset:1280
    ds_read_b64_tr_b16 v[240:241], v1 offset:2048
    ds_read_b64_tr_b16 v[242:243], v1 offset:2304
    v_mul_f32 v228, v156, v156
    v_mul_f32 v229, v157, v157
    v_mul_f32 v230, v158, v158
    v_mul_f32_e64 v231, v159, v159
    v_fma_f32 v228, v160, v160, v228
    v_fma_f32 v229, v161, v161, v229
    v_fma_f32 v230, v162, v162, v230
    v_fma_f32 v231, v163, v163, v231
    v_fma_f32 v228, v164, v164, v228
    v_fma_f32 v229, v165, v165, v229
    v_fma_f32 v230, v166, v166, v230
    v_fma_f32 v231, v167, v167, v231
    v_fma_f32 v228, v168, v168, v228
    v_fma_f32 v229, v169, v169, v229
    v_fma_f32 v230, v170, v170, v230
    v_fma_f32 v231, v171, v171, v231
    v_fma_f32 v228, v172, v172, v228
    v_fma_f32 v229, v173, v173, v229
    v_fma_f32 v230, v174, v174, v230
    v_fma_f32 v231, v175, v175, v231
    v_fma_f32 v228, v176, v176, v228
    v_fma_f32 v229, v177, v177, v229
    v_fma_f32 v230, v178, v178, v230
    v_fma_f32 v231, v179, v179, v231
    v_fma_f32 v228, v180, v180, v228
    v_fma_f32 v229, v181, v181, v229
    v_fma_f32 v230, v182, v182, v230
    v_fma_f32 v231, v183, v183, v231
    v_fma_f32 v228, v184, v184, v228
    v_fma_f32 v229, v185, v185, v229
    v_fma_f32 v230, v186, v186, v230
    v_fma_f32 v231, v187, v187, v231
    v_fma_f32 v228, v188, v188, v228
    v_fma_f32 v229, v189, v189, v229
    v_fma_f32 v230, v190, v190, v230
    v_fma_f32 v231, v191, v191, v231
    v_fma_f32 v228, v192, v192, v228
    v_fma_f32 v229, v193, v193, v229
    v_fma_f32 v230, v194, v194, v230
    v_fma_f32 v231, v195, v195, v231
    v_fma_f32 v228, v196, v196, v228
    v_fma_f32 v229, v197, v197, v229
    v_fma_f32 v230, v198, v198, v230
    v_fma_f32 v231, v199, v199, v231
    v_fma_f32 v228, v200, v200, v228
    v_fma_f32 v229, v201, v201, v229
    v_fma_f32 v230, v202, v202, v230
    v_fma_f32 v231, v203, v203, v231
    v_add_f32 v228, v228, v229
    v_add_f32 v230, v230, v231
    v_add_f32 v228, v228, v230
    v_mov_b32 v9, v228
    s_nop 1
    v_permlane32_swap_b32 v9, v228
    v_add_f32 v228, v228, v9
    v_fma_f32 v228, v228, s32, v11
    v_rsq_f32 v8, v228
    s_waitcnt lgkmcnt(9)
    v_fma_f32 v124, v124, v36, v20
    v_fma_f32 v125, v125, v37, v21
    v_fma_f32 v126, v126, v38, v22
    v_fma_f32 v127, v127, v39, v23
    s_waitcnt lgkmcnt(8)
    v_fma_f32 v128, v128, v40, v24
    v_fma_f32 v129, v129, v41, v25
    v_fma_f32 v130, v130, v42, v26
    v_fma_f32 v131, v131, v43, v27
    s_waitcnt lgkmcnt(7)
    v_fma_f32 v132, v132, v44, v28
    v_fma_f32 v133, v133, v45, v29
    v_fma_f32 v134, v134, v46, v30
    v_fma_f32 v135, v135, v47, v31
    s_waitcnt lgkmcnt(6)
    v_fma_f32 v136, v136, v48, v32
    v_fma_f32 v137, v137, v49, v33
    v_fma_f32 v138, v138, v50, v34
    v_fma_f32 v139, v139, v51, v35
    ds_read_b128 v[20:23], v5 offset:2176
    ds_read_b128 v[24:27], v5 offset:2208
    ds_read_b128 v[28:31], v5 offset:2240
    ds_read_b128 v[32:35], v5 offset:2272
    ds_read_b128 v[204:207], v5 offset:1792
    ds_read_b128 v[208:211], v5 offset:1824
    ds_read_b128 v[212:215], v5 offset:1856
    ds_read_b128 v[216:219], v5 offset:1888
    v_mul_f32 v156, v8, v156
    v_mul_f32 v157, v8, v157
    v_mul_f32 v158, v8, v158
    v_mul_f32 v159, v8, v159
    v_mul_f32 v160, v8, v160
    v_mul_f32 v161, v8, v161
    v_mul_f32 v162, v8, v162
    v_mul_f32 v163, v8, v163
    v_mul_f32 v164, v8, v164
    v_mul_f32 v165, v8, v165
    v_mul_f32 v166, v8, v166
    v_mul_f32 v167, v8, v167
    v_mul_f32 v168, v8, v168
    v_mul_f32 v169, v8, v169
    v_mul_f32_e64 v170, v8, v170
    v_mul_f32 v171, v8, v171
    s_waitcnt lgkmcnt(4)
    v_mfma_f32_32x32x16_bf16 v[20:35], v[12:15], v[76:79], v[20:35]
    v_mfma_f32_32x32x16_bf16 v[20:35], v[16:19], v[80:83], v[20:35]
    v_cvt_pk_bf16_f32 v36, v156, v157
    v_cvt_pk_bf16_f32 v37, v158, v159
    v_cvt_pk_bf16_f32 v38, v160, v161
    v_cvt_pk_bf16_f32 v39, v162, v163
    v_cvt_pk_bf16_f32 v40, v164, v165
    v_cvt_pk_bf16_f32 v41, v166, v167
    v_cvt_pk_bf16_f32 v42, v168, v169
    v_cvt_pk_bf16_f32 v43, v170, v171
    ds_read_b128 v[156:159], v5 offset:0
    ds_read_b128 v[160:163], v5 offset:32
    ds_read_b128 v[164:167], v5 offset:64
    ds_read_b128 v[168:171], v5 offset:96
    v_mul_f32 v172, v8, v172
    v_mul_f32 v173, v8, v173
    v_mul_f32 v174, v8, v174
    v_mul_f32 v175, v8, v175
    v_mul_f32 v176, v8, v176
    v_mul_f32 v177, v8, v177
    v_mul_f32 v178, v8, v178
    v_mul_f32 v179, v8, v179
    v_mul_f32 v180, v8, v180
    v_mul_f32 v181, v8, v181
    v_mul_f32 v182, v8, v182
    v_mul_f32 v183, v8, v183
    v_mul_f32 v184, v8, v184
    v_mul_f32 v185, v8, v185
    v_mul_f32 v186, v8, v186
    v_mul_f32 v187, v8, v187
    v_cvt_pk_bf16_f32 v44, v172, v173
    v_cvt_pk_bf16_f32 v45, v174, v175
    v_cvt_pk_bf16_f32 v46, v176, v177
    v_cvt_pk_bf16_f32 v47, v178, v179
    v_cvt_pk_bf16_f32 v48, v180, v181
    v_cvt_pk_bf16_f32 v49, v182, v183
    v_cvt_pk_bf16_f32 v50, v184, v185
    v_cvt_pk_bf16_f32 v51, v186, v187
    v_mul_f32 v188, v8, v188
    v_mul_f32 v189, v8, v189
    v_mul_f32 v190, v8, v190
    v_mul_f32 v191, v8, v191
    v_mul_f32 v192, v8, v192
    v_mul_f32 v193, v8, v193
    v_mul_f32 v194, v8, v194
    v_mul_f32 v195, v8, v195
    v_mul_f32 v196, v8, v196
    v_mul_f32 v197, v8, v197
    v_mul_f32 v198, v8, v198
    v_mul_f32 v199, v8, v199
    v_mul_f32 v200, v8, v200
    v_mul_f32 v201, v8, v201
    v_mul_f32 v202, v8, v202
    v_mul_f32 v203, v8, v203
    v_cvt_pk_bf16_f32 v52, v188, v189
    v_cvt_pk_bf16_f32 v53, v190, v191
    v_cvt_pk_bf16_f32 v54, v192, v193
    v_cvt_pk_bf16_f32 v55, v194, v195
    v_cvt_pk_bf16_f32 v56, v196, v197
    v_cvt_pk_bf16_f32 v57, v198, v199
    v_cvt_pk_bf16_f32 v58, v200, v201
    v_cvt_pk_bf16_f32 v59, v202, v203
    s_waitcnt lgkmcnt(0)
    v_mfma_f32_32x32x16_bf16 v[156:171], v[232:235], v[36:39], v[156:171]
    ds_read_b64_tr_b16 v[232:233], v1 offset:3072
    ds_read_b64_tr_b16 v[234:235], v1 offset:3328
    v_mfma_f32_32x32x16_bf16 v[156:171], v[236:239], v[40:43], v[156:171]
    ds_read_b64_tr_b16 v[236:237], v1 offset:4096
    ds_read_b64_tr_b16 v[238:239], v1 offset:4352
    v_mfma_f32_32x32x16_bf16 v[156:171], v[240:243], v[44:47], v[156:171]
    ds_read_b64_tr_b16 v[240:241], v1 offset:5120
    ds_read_b64_tr_b16 v[242:243], v1 offset:5376
    v_cvt_pk_bf16_f32 v124, v124, v125
    v_cvt_pk_bf16_f32 v125, v126, v127
    v_cvt_pk_bf16_f32 v126, v128, v129
    v_cvt_pk_bf16_f32 v127, v130, v131
    v_cvt_pk_bf16_f32 v128, v132, v133
    v_cvt_pk_bf16_f32 v129, v134, v135
    v_cvt_pk_bf16_f32 v130, v136, v137
    v_cvt_pk_bf16_f32 v131, v138, v139
    s_mov_b64 vcc, s[54:55]
    v_cndmask_b32_dpp v68, v128, v124, vcc quad_perm:[1,0,3,2] row_mask:0xf bank_mask:0xf
    v_cndmask_b32_dpp v69, v129, v125, vcc quad_perm:[1,0,3,2] row_mask:0xf bank_mask:0xf
    v_cndmask_b32_dpp v70, v130, v126, vcc quad_perm:[1,0,3,2] row_mask:0xf bank_mask:0xf
    v_cndmask_b32_dpp v71, v131, v127, vcc quad_perm:[1,0,3,2] row_mask:0xf bank_mask:0xf
    s_not_b64 vcc, vcc
    v_cndmask_b32_dpp v72, v124, v128, vcc quad_perm:[1,0,3,2] row_mask:0xf bank_mask:0xf
    v_cndmask_b32_dpp v73, v125, v129, vcc quad_perm:[1,0,3,2] row_mask:0xf bank_mask:0xf
    v_cndmask_b32_dpp v74, v126, v130, vcc quad_perm:[1,0,3,2] row_mask:0xf bank_mask:0xf
    v_cndmask_b32_dpp v75, v127, v131, vcc quad_perm:[1,0,3,2] row_mask:0xf bank_mask:0xf
    s_waitcnt lgkmcnt(4)
    v_mfma_f32_32x32x16_bf16 v[156:171], v[232:235], v[48:51], v[156:171]
    ds_read_b64_tr_b16 v[232:233], v1 offset:6144
    ds_read_b64_tr_b16 v[234:235], v1 offset:6400
    s_waitcnt lgkmcnt(4)
    v_mfma_f32_32x32x16_bf16 v[156:171], v[236:239], v[52:55], v[156:171]
    ds_read_b64_tr_b16 v[236:237], v1 offset:7168
    ds_read_b64_tr_b16 v[238:239], v1 offset:7424
    s_waitcnt lgkmcnt(4)
    v_mfma_f32_32x32x16_bf16 v[156:171], v[240:243], v[56:59], v[156:171]
    ds_read_b64_tr_b16 v[240:241], v1 offset:8192
    ds_read_b64_tr_b16 v[242:243], v1 offset:8448
    ds_read_b128 v[172:175], v5 offset:128
    ds_read_b128 v[176:179], v5 offset:160
    ds_read_b128 v[180:183], v5 offset:192
    ds_read_b128 v[184:187], v5 offset:224
    v_fma_f32 v140, v140, v204, v20
    v_fma_f32 v141, v141, v205, v21
    v_fma_f32 v142, v142, v206, v22
    v_fma_f32 v143, v143, v207, v23
    v_fma_f32 v144, v144, v208, v24
    v_fma_f32 v145, v145, v209, v25
    v_fma_f32 v146, v146, v210, v26
    v_fma_f32 v147, v147, v211, v27
    v_fma_f32 v148, v148, v212, v28
    v_fma_f32 v149, v149, v213, v29
    v_fma_f32 v150, v150, v214, v30
    v_fma_f32 v151, v151, v215, v31
    v_fma_f32 v152, v152, v216, v32
    v_fma_f32 v153, v153, v217, v33
    v_fma_f32 v154, v154, v218, v34
    v_fma_f32 v155, v155, v219, v35
    v_cvt_pk_bf16_f32 v140, v140, v141
    v_cvt_pk_bf16_f32 v141, v142, v143
    v_cvt_pk_bf16_f32 v142, v144, v145
    v_cvt_pk_bf16_f32 v143, v146, v147
    v_cvt_pk_bf16_f32 v144, v148, v149
    v_cvt_pk_bf16_f32 v145, v150, v151
    v_cvt_pk_bf16_f32 v146, v152, v153
    v_cvt_pk_bf16_f32 v147, v154, v155
    s_mov_b64 vcc, s[54:55]
    v_cndmask_b32_dpp v76, v144, v140, vcc quad_perm:[1,0,3,2] row_mask:0xf bank_mask:0xf
    v_cndmask_b32_dpp v77, v145, v141, vcc quad_perm:[1,0,3,2] row_mask:0xf bank_mask:0xf
    v_cndmask_b32_dpp v78, v146, v142, vcc quad_perm:[1,0,3,2] row_mask:0xf bank_mask:0xf
    v_cndmask_b32_dpp v79, v147, v143, vcc quad_perm:[1,0,3,2] row_mask:0xf bank_mask:0xf
    s_not_b64 vcc, vcc
    v_cndmask_b32_dpp v80, v140, v144, vcc quad_perm:[1,0,3,2] row_mask:0xf bank_mask:0xf
    v_cndmask_b32_dpp v81, v141, v145, vcc quad_perm:[1,0,3,2] row_mask:0xf bank_mask:0xf
    v_cndmask_b32_dpp v82, v142, v146, vcc quad_perm:[1,0,3,2] row_mask:0xf bank_mask:0xf
    v_cndmask_b32_dpp v83, v143, v147, vcc quad_perm:[1,0,3,2] row_mask:0xf bank_mask:0xf
L_stepsA:
    s_waitcnt lgkmcnt(0)
    v_fma_f32 v204, -v156, v156, s30
    v_fma_f32 v205, -v157, v157, s30
    v_fma_f32 v206, -v158, v158, s30
    v_fma_f32 v207, -v159, v159, s30
    v_fma_f32 v208, -v160, v160, s30
    v_fma_f32 v209, -v161, v161, s30
    v_fma_f32 v210, -v162, v162, s30
    v_fma_f32 v211, -v163, v163, s30
    v_mul_f32 v204, v204, v156
    v_mul_f32 v205, v205, v157
    v_mul_f32 v206, v206, v158
    v_mul_f32 v207, v207, v159
    v_mul_f32 v208, v208, v160
    v_mul_f32 v209, v209, v161
    v_mul_f32 v210, v210, v162
    v_mul_f32_e64 v211, v211, v163
    s_setprio 1
    s_waitcnt lgkmcnt(0)
    v_mfma_f32_32x32x16_bf16 v[172:187], v[232:235], v[36:39], v[172:187]
    v_exp_f32 v204, v204
    v_exp_f32 v205, v205
    v_exp_f32_e64 v206, v206
    v_mfma_f32_32x32x16_bf16 v[172:187], v[236:239], v[40:43], v[172:187]
    v_exp_f32 v207, v207
    v_exp_f32 v208, v208
    v_exp_f32_e64 v209, v209
    v_mfma_f32_32x32x16_bf16 v[172:187], v[240:243], v[44:47], v[172:187]
    v_exp_f32_e64 v210, v210
    v_exp_f32 v211, v211
    s_setprio 0
    ds_read_b64_tr_b16 v[232:233], v1 offset:9216
    ds_read_b64_tr_b16 v[234:235], v1 offset:9472
    ds_read_b64_tr_b16 v[236:237], v1 offset:10240
    ds_read_b64_tr_b16 v[238:239], v1 offset:10496
    ds_read_b64_tr_b16 v[240:241], v1 offset:11264
    ds_read_b64_tr_b16 v[242:243], v1 offset:11520
    ds_read_b128 v[188:191], v5 offset:256
    ds_read_b128 v[192:195], v5 offset:288
    buffer_store_dwordx4 v[60:63], v10, s[8:11], s28 offen offset:0 nt
    s_cmp_lg_u32 s26, 4
    s_cbranch_scc1 L_nb0_0
    s_waitcnt vmcnt(1)
    s_barrier
    s_add_u32 m0, s23, 36864
    s_nop 0
    buffer_load_dwordx4 v20, s[12:15], s70 offen lds
    s_add_u32 m0, s23, 40960
    s_nop 0
    buffer_load_dwordx4 v20, s[12:15], s71 offen lds
    s_add_u32 m0, s23, 45056
    s_nop 0
    buffer_load_dwordx4 v20, s[12:15], s72 offen lds
    v_add_u32 v20, s22, v20
L_nb0_0:
    v_add_f32 v204, 1.0, v204
    v_add_f32 v205, 1.0, v205
    v_add_f32 v206, 1.0, v206
    v_add_f32 v207, 1.0, v207
    v_add_f32 v208, 1.0, v208
    v_add_f32 v209, 1.0, v209
    v_add_f32 v210, 1.0, v210
    v_add_f32 v211, 1.0, v211
    v_fma_f32 v212, -v164, v164, s30
    v_fma_f32 v213, -v165, v165, s30
    v_fma_f32 v214, -v166, v166, s30
    v_fma_f32 v215, -v167, v167, s30
    v_fma_f32 v216, -v168, v168, s30
    v_fma_f32 v217, -v169, v169, s30
    v_fma_f32 v218, -v170, v170, s30
    v_fma_f32 v219, -v171, v171, s30
    v_mul_f32 v212, v212, v164
    v_mul_f32 v213, v213, v165
    v_mul_f32 v214, v214, v166
    v_mul_f32 v215, v215, v167
    v_mul_f32 v216, v216, v168
    v_mul_f32 v217, v217, v169
    v_mul_f32 v218, v218, v170
    v_mul_f32 v219, v219, v171
    s_setprio 1
    s_waitcnt lgkmcnt(0)
    v_mfma_f32_32x32x16_bf16 v[172:187], v[232:235], v[48:51], v[172:187]
    v_rcp_f32 v204, v204
    v_rcp_f32 v205, v205
    v_rcp_f32 v206, v206
    v_rcp_f32 v207, v207
    v_rcp_f32 v208, v208
    v_rcp_f32 v209, v209
    v_mfma_f32_32x32x16_bf16 v[172:187], v[236:239], v[52:55], v[172:187]
    v_rcp_f32 v210, v210
    v_rcp_f32 v211, v211
    v_exp_f32 v212, v212
    v_exp_f32 v213, v213
    v_exp_f32_e64 v214, v214
    v_mfma_f32_32x32x16_bf16 v[172:187], v[240:243], v[56:59], v[172:187]
    v_exp_f32 v215, v215
    v_exp_f32 v216, v216
    v_exp_f32 v217, v217
    v_exp_f32 v218, v218
    v_exp_f32 v219, v219
    s_setprio 0
    ds_read_b64_tr_b16 v[232:233], v1 offset:12288
    ds_read_b64_tr_b16 v[234:235], v1 offset:12544
    ds_read_b64_tr_b16 v[236:237], v1 offset:13312
    ds_read_b64_tr_b16 v[238:239], v1 offset:13568
    ds_read_b64_tr_b16 v[240:241], v1 offset:14336
    ds_read_b64_tr_b16 v[242:243], v1 offset:14592
    ds_read_b64_tr_b16 v[244:245], v3 offset:0
    ds_read_b64_tr_b16 v[246:247], v3 offset:512
    ds_read_b64_tr_b16 v[248:249], v3 offset:1024
    ds_read_b64_tr_b16 v[250:251], v3 offset:1536
    ds_read_b64_tr_b16 v[252:253], v3 offset:2048
    ds_read_b64_tr_b16 v[254:255], v3 offset:2560
    ds_read_b128 v[196:199], v5 offset:320
    ds_read_b128 v[200:203], v5 offset:352
    buffer_store_dwordx4 v[64:67], v10, s[8:11], s28 offen offset:192 nt
    s_cmp_lg_u32 s26, 4
    s_cbranch_scc1 L_ng1_0
    s_add_u32 m0, s23, 49152
    s_nop 0
    buffer_load_dwordx4 v20, s[12:15], s70 offen lds
    s_add_u32 m0, s23, 53248
    s_nop 0
    buffer_load_dwordx4 v20, s[12:15], s71 offen lds
    s_add_u32 m0, s23, 57344
    s_nop 0
    buffer_load_dwordx4 v20, s[12:15], s72 offen lds
    v_add_u32 v20, s22, v20
L_ng1_0:
    v_mul_f32 v204, v204, v156
    v_mul_f32 v205, v205, v157
    v_mul_f32 v206, v206, v158
    v_mul_f32 v207, v207, v159
    v_mul_f32 v208, v208, v160
    v_mul_f32 v209, v209, v161
    v_mul_f32 v210, v210, v162
    v_mul_f32 v211, v211, v163
    v_add_f32 v212, 1.0, v212
    v_add_f32 v213, 1.0, v213
    v_add_f32 v214, 1.0, v214
    v_add_f32 v215, 1.0, v215
    v_add_f32 v216, 1.0, v216
    v_add_f32 v217, 1.0, v217
    v_add_f32 v218, 1.0, v218
    v_add_f32 v219, 1.0, v219
    v_fma_f32 v220, -v172, v172, s30
    v_fma_f32 v221, -v173, v173, s30
    v_fma_f32 v222, -v174, v174, s30
    v_fma_f32 v223, -v175, v175, s30
    v_fma_f32 v224, -v176, v176, s30
    v_fma_f32 v225, -v177, v177, s30
    v_fma_f32 v226, -v178, v178, s30
    v_fma_f32 v227, -v179, v179, s30
    v_mul_f32 v220, v220, v172
    v_mul_f32 v221, v221, v173
    v_mul_f32 v222, v222, v174
    v_mul_f32 v223, v223, v175
    v_mul_f32 v224, v224, v176
    v_mul_f32 v225, v225, v177
    v_mul_f32 v226, v226, v178
    v_mul_f32 v227, v227, v179
    s_setprio 1
    s_waitcnt lgkmcnt(0)
    v_mfma_f32_32x32x16_bf16 v[188:203], v[232:235], v[36:39], v[188:203]
    v_cvt_pk_bf16_f32 v228, v204, v205
    v_cvt_pk_bf16_f32 v229, v206, v207
    v_cvt_pk_bf16_f32 v230, v208, v209
    v_cvt_pk_bf16_f32 v231, v210, v211
    v_rcp_f32_e64 v212, v212
    v_mfma_f32_32x32x16_bf16 v[188:203], v[236:239], v[40:43], v[188:203]
    v_rcp_f32 v213, v213
    v_rcp_f32 v214, v214
    v_rcp_f32_e64 v215, v215
    v_mfma_f32_32x32x16_bf16 v[188:203], v[240:243], v[44:47], v[188:203]
    v_rcp_f32 v216, v216
    v_rcp_f32 v217, v217
    v_rcp_f32_e64 v218, v218
    v_mfma_f32_32x32x16_bf16 v[108:123], v[244:247], v[228:231], 0
    v_rcp_f32 v219, v219
    v_exp_f32 v220, v220
    v_exp_f32_e64 v221, v221
    v_mfma_f32_32x32x16_bf16 v[124:139], v[248:251], v[228:231], 0
    v_exp_f32 v222, v222
    v_exp_f32 v223, v223
    v_exp_f32_e64 v224, v224
    v_mfma_f32_32x32x16_bf16 v[140:155], v[252:255], v[228:231], 0
    v_exp_f32 v225, v225
    v_exp_f32 v226, v226
    v_exp_f32 v227, v227
    s_setprio 0
    ds_read_b64_tr_b16 v[232:233], v1 offset:15360
    ds_read_b64_tr_b16 v[234:235], v1 offset:15616
    ds_read_b64_tr_b16 v[236:237], v1 offset:16384
    ds_read_b64_tr_b16 v[238:239], v1 offset:16640
    ds_read_b64_tr_b16 v[240:241], v1 offset:17408
    ds_read_b64_tr_b16 v[242:243], v1 offset:17664
    ds_read_b64_tr_b16 v[244:245], v3 offset:3072
    ds_read_b64_tr_b16 v[246:247], v3 offset:3584
    ds_read_b64_tr_b16 v[248:249], v3 offset:4096
    ds_read_b64_tr_b16 v[250:251], v3 offset:4608
    ds_read_b64_tr_b16 v[252:253], v3 offset:5120
    ds_read_b64_tr_b16 v[254:255], v3 offset:5632
    ds_read_b128 v[156:159], v5 offset:384
    ds_read_b128 v[160:163], v5 offset:416
    buffer_store_dwordx4 v[68:71], v10, s[8:11], s28 offen offset:64 nt
    s_cmp_lg_u32 s26, 4
    s_cbranch_scc1 L_ng2_0
    s_add_u32 m0, s23, 61440
    s_nop 0
    buffer_load_dwordx4 v20, s[12:15], s70 offen lds
    s_add_u32 m0, s23, 65536
    s_nop 0
    buffer_load_dwordx4 v20, s[12:15], s71 offen lds
    s_add_u32 m0, s23, 69632
    s_nop 0
    buffer_load_dwordx4 v20, s[12:15], s72 offen lds
L_ng2_0:
    v_mul_f32 v212, v212, v164
    v_mul_f32 v213, v213, v165
    v_mul_f32 v214, v214, v166
    v_mul_f32 v215, v215, v167
    v_mul_f32 v216, v216, v168
    v_mul_f32 v217, v217, v169
    v_mul_f32 v218, v218, v170
    v_mul_f32 v219, v219, v171
    v_add_f32 v220, 1.0, v220
    v_add_f32 v221, 1.0, v221
    v_add_f32 v222, 1.0, v222
    v_add_f32 v223, 1.0, v223
    v_add_f32 v224, 1.0, v224
    v_add_f32 v225, 1.0, v225
    v_add_f32 v226, 1.0, v226
    v_add_f32_e64 v227, 1.0, v227
    v_fma_f32 v204, -v180, v180, s30
    v_fma_f32 v205, -v181, v181, s30
    v_fma_f32 v206, -v182, v182, s30
    v_fma_f32 v207, -v183, v183, s30
    v_fma_f32 v208, -v184, v184, s30
    v_fma_f32 v209, -v185, v185, s30
    v_fma_f32 v210, -v186, v186, s30
    v_fma_f32 v211, -v187, v187, s30
    v_mul_f32 v204, v204, v180
    v_mul_f32 v205, v205, v181
    v_mul_f32 v206, v206, v182
    v_mul_f32 v207, v207, v183
    v_mul_f32 v208, v208, v184
    v_mul_f32 v209, v209, v185
    v_mul_f32 v210, v210, v186
    v_mul_f32 v211, v211, v187
    s_setprio 1
    s_waitcnt lgkmcnt(0)
    v_mfma_f32_32x32x16_bf16 v[188:203], v[232:235], v[48:51], v[188:203]
    v_cvt_pk_bf16_f32 v228, v212, v213
    v_cvt_pk_bf16_f32 v229, v214, v215
    v_cvt_pk_bf16_f32 v230, v216, v217
    v_cvt_pk_bf16_f32 v231, v218, v219
    v_rcp_f32_e64 v220, v220
    v_mfma_f32_32x32x16_bf16 v[188:203], v[236:239], v[52:55], v[188:203]
    v_rcp_f32 v221, v221
    v_rcp_f32 v222, v222
    v_rcp_f32_e64 v223, v223
    v_mfma_f32_32x32x16_bf16 v[188:203], v[240:243], v[56:59], v[188:203]
    v_rcp_f32 v224, v224
    v_rcp_f32 v225, v225
    v_rcp_f32_e64 v226, v226
    v_mfma_f32_32x32x16_bf16 v[108:123], v[244:247], v[228:231], v[108:123]
    v_rcp_f32 v227, v227
    v_exp_f32 v204, v204
    v_exp_f32_e64 v205, v205
    v_mfma_f32_32x32x16_bf16 v[124:139], v[248:251], v[228:231], v[124:139]
    v_exp_f32 v206, v206
    v_exp_f32 v207, v207
    v_exp_f32_e64 v208, v208
    v_mfma_f32_32x32x16_bf16 v[140:155], v[252:255], v[228:231], v[140:155]
    v_exp_f32 v209, v209
    v_exp_f32 v210, v210
    v_exp_f32 v211, v211
    s_setprio 0
    ds_read_b64_tr_b16 v[232:233], v1 offset:18432
    ds_read_b64_tr_b16 v[234:235], v1 offset:18688
    ds_read_b64_tr_b16 v[236:237], v1 offset:19456
    ds_read_b64_tr_b16 v[238:239], v1 offset:19712
    ds_read_b64_tr_b16 v[240:241], v1 offset:20480
    ds_read_b64_tr_b16 v[242:243], v1 offset:20736
    ds_read_b64_tr_b16 v[244:245], v3 offset:6144
    ds_read_b64_tr_b16 v[246:247], v3 offset:6656
    ds_read_b64_tr_b16 v[248:249], v3 offset:7168
    ds_read_b64_tr_b16 v[250:251], v3 offset:7680
    ds_read_b64_tr_b16 v[252:253], v3 offset:8192
    ds_read_b64_tr_b16 v[254:255], v3 offset:8704
    ds_read_b128 v[164:167], v5 offset:448
    ds_read_b128 v[168:171], v5 offset:480
    buffer_store_dwordx4 v[72:75], v10, s[8:11], s28 offen offset:256 nt
    v_mul_f32 v220, v220, v172
    v_mul_f32 v221, v221, v173
    v_mul_f32 v222, v222, v174
    v_mul_f32 v223, v223, v175
    v_mul_f32 v224, v224, v176
    v_mul_f32 v225, v225, v177
    v_mul_f32 v226, v226, v178
    v_mul_f32 v227, v227, v179
    v_add_f32 v204, 1.0, v204
    v_add_f32 v205, 1.0, v205
    v_add_f32 v206, 1.0, v206
    v_add_f32 v207, 1.0, v207
    v_add_f32 v208, 1.0, v208
    v_add_f32 v209, 1.0, v209
    v_add_f32 v210, 1.0, v210
    v_add_f32 v211, 1.0, v211
    v_fma_f32 v212, -v188, v188, s30
    v_fma_f32 v213, -v189, v189, s30
    v_fma_f32 v214, -v190, v190, s30
    v_fma_f32 v215, -v191, v191, s30
    v_fma_f32 v216, -v192, v192, s30
    v_fma_f32 v217, -v193, v193, s30
    v_fma_f32 v218, -v194, v194, s30
    v_fma_f32 v219, -v195, v195, s30
    v_mul_f32 v212, v212, v188
    v_mul_f32 v213, v213, v189
    v_mul_f32 v214, v214, v190
    v_mul_f32 v215, v215, v191
    v_mul_f32 v216, v216, v192
    v_mul_f32 v217, v217, v193
    v_mul_f32 v218, v218, v194
    v_mul_f32 v219, v219, v195
    s_setprio 1
    s_waitcnt lgkmcnt(0)
    v_mfma_f32_32x32x16_bf16 v[156:171], v[232:235], v[36:39], v[156:171]
    v_cvt_pk_bf16_f32 v228, v220, v221
    v_cvt_pk_bf16_f32 v229, v222, v223
    v_cvt_pk_bf16_f32 v230, v224, v225
    v_cvt_pk_bf16_f32 v231, v226, v227
    v_rcp_f32_e64 v204, v204
    v_mfma_f32_32x32x16_bf16 v[156:171], v[236:239], v[40:43], v[156:171]
    v_rcp_f32 v205, v205
    v_rcp_f32 v206, v206
    v_rcp_f32_e64 v207, v207
    v_mfma_f32_32x32x16_bf16 v[156:171], v[240:243], v[44:47], v[156:171]
    v_rcp_f32 v208, v208
    v_rcp_f32 v209, v209
    v_rcp_f32_e64 v210, v210
    v_mfma_f32_32x32x16_bf16 v[108:123], v[244:247], v[228:231], v[108:123]
    v_rcp_f32 v211, v211
    v_exp_f32 v212, v212
    v_exp_f32_e64 v213, v213
    v_mfma_f32_32x32x16_bf16 v[124:139], v[248:251], v[228:231], v[124:139]
    v_exp_f32 v214, v214
    v_exp_f32 v215, v215
    v_exp_f32_e64 v216, v216
    v_mfma_f32_32x32x16_bf16 v[140:155], v[252:255], v[228:231], v[140:155]
    v_exp_f32 v217, v217
    v_exp_f32 v218, v218
    v_exp_f32 v219, v219
    s_setprio 0
    ds_read_b64_tr_b16 v[232:233], v1 offset:21504
    ds_read_b64_tr_b16 v[234:235], v1 offset:21760
    ds_read_b64_tr_b16 v[236:237], v1 offset:22528
    ds_read_b64_tr_b16 v[238:239], v1 offset:22784
    ds_read_b64_tr_b16 v[240:241], v1 offset:23552
    ds_read_b64_tr_b16 v[242:243], v1 offset:23808
    ds_read_b64_tr_b16 v[244:245], v3 offset:9216
    ds_read_b64_tr_b16 v[246:247], v3 offset:9728
    ds_read_b64_tr_b16 v[248:249], v3 offset:10240
    ds_read_b64_tr_b16 v[250:251], v3 offset:10752
    ds_read_b64_tr_b16 v[252:253], v3 offset:11264
    ds_read_b64_tr_b16 v[254:255], v3 offset:11776
    ds_read_b128 v[172:175], v5 offset:512
    ds_read_b128 v[176:179], v5 offset:544
    buffer_store_dwordx4 v[76:79], v10, s[8:11], s28 offen offset:128 nt
    v_mul_f32 v204, v204, v180
    v_mul_f32 v205, v205, v181
    v_mul_f32 v206, v206, v182
    v_mul_f32 v207, v207, v183
    v_mul_f32 v208, v208, v184
    v_mul_f32 v209, v209, v185
    v_mul_f32 v210, v210, v186
    v_mul_f32 v211, v211, v187
    v_add_f32 v212, 1.0, v212
    v_add_f32 v213, 1.0, v213
    v_add_f32 v214, 1.0, v214
    v_add_f32 v215, 1.0, v215
    v_add_f32 v216, 1.0, v216
    v_add_f32 v217, 1.0, v217
    v_add_f32 v218, 1.0, v218
    v_add_f32 v219, 1.0, v219
    v_fma_f32 v220, -v196, v196, s30
    v_fma_f32 v221, -v197, v197, s30
    v_fma_f32 v222, -v198, v198, s30
    v_fma_f32 v223, -v199, v199, s30
    v_fma_f32 v224, -v200, v200, s30
    v_fma_f32 v225, -v201, v201, s30
    v_fma_f32 v226, -v202, v202, s30
    v_fma_f32 v227, -v203, v203, s30
    v_mul_f32 v220, v220, v196
    v_mul_f32 v221, v221, v197
    v_mul_f32 v222, v222, v198
    v_mul_f32 v223, v223, v199
    v_mul_f32 v224, v224, v200
    v_mul_f32 v225, v225, v201
    v_mul_f32 v226, v226, v202
    v_mul_f32 v227, v227, v203
    s_setprio 1
    s_waitcnt lgkmcnt(0)
    v_mfma_f32_32x32x16_bf16 v[156:171], v[232:235], v[48:51], v[156:171]
    v_cvt_pk_bf16_f32 v228, v204, v205
    v_cvt_pk_bf16_f32 v229, v206, v207
    v_cvt_pk_bf16_f32 v230, v208, v209
    v_cvt_pk_bf16_f32 v231, v210, v211
    v_rcp_f32_e64 v212, v212
    v_mfma_f32_32x32x16_bf16 v[156:171], v[236:239], v[52:55], v[156:171]
    v_rcp_f32 v213, v213
    v_rcp_f32 v214, v214
    v_rcp_f32_e64 v215, v215
    v_mfma_f32_32x32x16_bf16 v[156:171], v[240:243], v[56:59], v[156:171]
    v_rcp_f32 v216, v216
    v_rcp_f32 v217, v217
    v_rcp_f32_e64 v218, v218
    v_mfma_f32_32x32x16_bf16 v[108:123], v[244:247], v[228:231], v[108:123]
    v_rcp_f32 v219, v219
    v_exp_f32 v220, v220
    v_exp_f32_e64 v221, v221
    v_mfma_f32_32x32x16_bf16 v[124:139], v[248:251], v[228:231], v[124:139]
    v_exp_f32 v222, v222
    v_exp_f32 v223, v223
    v_exp_f32_e64 v224, v224
    v_mfma_f32_32x32x16_bf16 v[140:155], v[252:255], v[228:231], v[140:155]
    v_exp_f32 v225, v225
    v_exp_f32 v226, v226
    v_exp_f32 v227, v227
    s_setprio 0
    ds_read_b64_tr_b16 v[232:233], v1 offset:24576
    ds_read_b64_tr_b16 v[234:235], v1 offset:24832
    ds_read_b64_tr_b16 v[236:237], v1 offset:25600
    ds_read_b64_tr_b16 v[238:239], v1 offset:25856
    ds_read_b64_tr_b16 v[240:241], v1 offset:26624
    ds_read_b64_tr_b16 v[242:243], v1 offset:26880
    ds_read_b64_tr_b16 v[244:245], v3 offset:12288
    ds_read_b64_tr_b16 v[246:247], v3 offset:12800
    ds_read_b64_tr_b16 v[248:249], v3 offset:13312
    ds_read_b64_tr_b16 v[250:251], v3 offset:13824
    ds_read_b64_tr_b16 v[252:253], v3 offset:14336
    ds_read_b64_tr_b16 v[254:255], v3 offset:14848
    ds_read_b128 v[180:183], v5 offset:576
    ds_read_b128 v[184:187], v5 offset:608
    buffer_store_dwordx4 v[80:83], v10, s[8:11], s28 offen offset:320 nt
    v_mul_f32 v212, v212, v188
    v_mul_f32 v213, v213, v189
    v_mul_f32 v214, v214, v190
    v_mul_f32 v215, v215, v191
    v_mul_f32 v216, v216, v192
    v_mul_f32 v217, v217, v193
    v_mul_f32 v218, v218, v194
    v_mul_f32 v219, v219, v195
    v_add_f32 v220, 1.0, v220
    v_add_f32 v221, 1.0, v221
    v_add_f32 v222, 1.0, v222
    v_add_f32 v223, 1.0, v223
    v_add_f32 v224, 1.0, v224
    v_add_f32 v225, 1.0, v225
    v_add_f32 v226, 1.0, v226
    v_add_f32 v227, 1.0, v227
    v_fma_f32 v204, -v156, v156, s30
    v_fma_f32 v205, -v157, v157, s30
    v_fma_f32 v206, -v158, v158, s30
    v_fma_f32 v207, -v159, v159, s30
    v_fma_f32 v208, -v160, v160, s30
    v_fma_f32 v209, -v161, v161, s30
    v_fma_f32 v210, -v162, v162, s30
    v_fma_f32 v211, -v163, v163, s30
    v_mul_f32 v204, v204, v156
    v_mul_f32 v205, v205, v157
    v_mul_f32 v206, v206, v158
    v_mul_f32 v207, v207, v159
    v_mul_f32 v208, v208, v160
    v_mul_f32 v209, v209, v161
    v_mul_f32 v210, v210, v162
    v_mul_f32 v211, v211, v163
    s_setprio 1
    s_waitcnt lgkmcnt(0)
    v_mfma_f32_32x32x16_bf16 v[172:187], v[232:235], v[36:39], v[172:187]
    v_cvt_pk_bf16_f32 v228, v212, v213
    v_cvt_pk_bf16_f32 v229, v214, v215
    v_cvt_pk_bf16_f32 v230, v216, v217
    v_cvt_pk_bf16_f32 v231, v218, v219
    v_rcp_f32_e64 v220, v220
    v_mfma_f32_32x32x16_bf16 v[172:187], v[236:239], v[40:43], v[172:187]
    v_rcp_f32 v221, v221
    v_rcp_f32 v222, v222
    v_rcp_f32_e64 v223, v223
    v_mfma_f32_32x32x16_bf16 v[172:187], v[240:243], v[44:47], v[172:187]
    v_rcp_f32 v224, v224
    v_rcp_f32 v225, v225
    v_rcp_f32_e64 v226, v226
    v_mfma_f32_32x32x16_bf16 v[108:123], v[244:247], v[228:231], v[108:123]
    v_rcp_f32 v227, v227
    v_exp_f32 v204, v204
    v_exp_f32_e64 v205, v205
    v_mfma_f32_32x32x16_bf16 v[124:139], v[248:251], v[228:231], v[124:139]
    v_exp_f32 v206, v206
    v_exp_f32 v207, v207
    v_exp_f32_e64 v208, v208
    v_mfma_f32_32x32x16_bf16 v[140:155], v[252:255], v[228:231], v[140:155]
    v_exp_f32 v209, v209
    v_exp_f32 v210, v210
    v_exp_f32 v211, v211
    s_setprio 0
    ds_read_b64_tr_b16 v[232:233], v1 offset:27648
    ds_read_b64_tr_b16 v[234:235], v1 offset:27904
    ds_read_b64_tr_b16 v[236:237], v1 offset:28672
    ds_read_b64_tr_b16 v[238:239], v1 offset:28928
    ds_read_b64_tr_b16 v[240:241], v1 offset:29696
    ds_read_b64_tr_b16 v[242:243], v1 offset:29952
    ds_read_b64_tr_b16 v[244:245], v3 offset:15360
    ds_read_b64_tr_b16 v[246:247], v3 offset:15872
    ds_read_b64_tr_b16 v[248:249], v3 offset:16384
    ds_read_b64_tr_b16 v[250:251], v3 offset:16896
    ds_read_b64_tr_b16 v[252:253], v3 offset:17408
    ds_read_b64_tr_b16 v[254:255], v3 offset:17920
    ds_read_b128 v[188:191], v5 offset:640
    ds_read_b128 v[192:195], v5 offset:672
    v_mul_f32 v220, v220, v196
    v_mul_f32 v221, v221, v197
    v_mul_f32 v222, v222, v198
    v_mul_f32 v223, v223, v199
    v_mul_f32 v224, v224, v200
    v_mul_f32 v225, v225, v201
    v_mul_f32 v226, v226, v202
    v_mul_f32 v227, v227, v203
    v_add_f32 v204, 1.0, v204
    v_add_f32 v205, 1.0, v205
    v_add_f32 v206, 1.0, v206
    v_add_f32 v207, 1.0, v207
    v_add_f32 v208, 1.0, v208
    v_add_f32 v209, 1.0, v209
    v_add_f32 v210, 1.0, v210
    v_add_f32 v211, 1.0, v211
    v_fma_f32 v212, -v164, v164, s30
    v_fma_f32 v213, -v165, v165, s30
    v_fma_f32 v214, -v166, v166, s30
    v_fma_f32 v215, -v167, v167, s30
    v_fma_f32 v216, -v168, v168, s30
    v_fma_f32 v217, -v169, v169, s30
    v_fma_f32 v218, -v170, v170, s30
    v_fma_f32 v219, -v171, v171, s30
    v_mul_f32 v212, v212, v164
    v_mul_f32 v213, v213, v165
    v_mul_f32 v214, v214, v166
    v_mul_f32 v215, v215, v167
    v_mul_f32 v216, v216, v168
    v_mul_f32 v217, v217, v169
    v_mul_f32 v218, v218, v170
    v_mul_f32 v219, v219, v171
    s_setprio 1
    s_waitcnt lgkmcnt(0)
    v_mfma_f32_32x32x16_bf16 v[172:187], v[232:235], v[48:51], v[172:187]
    v_cvt_pk_bf16_f32 v228, v220, v221
    v_cvt_pk_bf16_f32 v229, v222, v223
    v_cvt_pk_bf16_f32 v230, v224, v225
    v_cvt_pk_bf16_f32 v231, v226, v227
    v_rcp_f32_e64 v204, v204
    v_mfma_f32_32x32x16_bf16 v[172:187], v[236:239], v[52:55], v[172:187]
    v_rcp_f32 v205, v205
    v_rcp_f32 v206, v206
    v_rcp_f32_e64 v207, v207
    v_mfma_f32_32x32x16_bf16 v[172:187], v[240:243], v[56:59], v[172:187]
    v_rcp_f32 v208, v208
    v_rcp_f32 v209, v209
    v_rcp_f32_e64 v210, v210
    v_mfma_f32_32x32x16_bf16 v[108:123], v[244:247], v[228:231], v[108:123]
    v_rcp_f32 v211, v211
    v_exp_f32 v212, v212
    v_exp_f32_e64 v213, v213
    v_mfma_f32_32x32x16_bf16 v[124:139], v[248:251], v[228:231], v[124:139]
    v_exp_f32 v214, v214
    v_exp_f32 v215, v215
    v_exp_f32_e64 v216, v216
    v_mfma_f32_32x32x16_bf16 v[140:155], v[252:255], v[228:231], v[140:155]
    v_exp_f32 v217, v217
    v_exp_f32 v218, v218
    v_exp_f32 v219, v219
    s_setprio 0
    ds_read_b64_tr_b16 v[232:233], v1 offset:30720
    ds_read_b64_tr_b16 v[234:235], v1 offset:30976
    ds_read_b64_tr_b16 v[236:237], v1 offset:31744
    ds_read_b64_tr_b16 v[238:239], v1 offset:32000
    ds_read_b64_tr_b16 v[240:241], v1 offset:32768
    ds_read_b64_tr_b16 v[242:243], v1 offset:33024
    ds_read_b64_tr_b16 v[244:245], v3 offset:18432
    ds_read_b64_tr_b16 v[246:247], v3 offset:18944
    ds_read_b64_tr_b16 v[248:249], v3 offset:19456
    ds_read_b64_tr_b16 v[250:251], v3 offset:19968
    ds_read_b64_tr_b16 v[252:253], v3 offset:20480
    ds_read_b64_tr_b16 v[254:255], v3 offset:20992
    ds_read_b128 v[196:199], v5 offset:704
    ds_read_b128 v[200:203], v5 offset:736
    v_mul_f32 v204, v204, v156
    v_mul_f32 v205, v205, v157
    v_mul_f32 v206, v206, v158
    v_mul_f32 v207, v207, v159
    v_mul_f32 v208, v208, v160
    v_mul_f32 v209, v209, v161
    v_mul_f32 v210, v210, v162
    v_mul_f32 v211, v211, v163
    v_add_f32 v212, 1.0, v212
    v_add_f32 v213, 1.0, v213
    v_add_f32 v214, 1.0, v214
    v_add_f32 v215, 1.0, v215
    v_add_f32 v216, 1.0, v216
    v_add_f32 v217, 1.0, v217
    v_add_f32 v218, 1.0, v218
    v_add_f32 v219, 1.0, v219
    v_fma_f32 v220, -v172, v172, s30
    v_fma_f32 v221, -v173, v173, s30
    v_fma_f32 v222, -v174, v174, s30
    v_fma_f32 v223, -v175, v175, s30
    v_fma_f32 v224, -v176, v176, s30
    v_fma_f32 v225, -v177, v177, s30
    v_fma_f32 v226, -v178, v178, s30
    v_fma_f32 v227, -v179, v179, s30
    v_mul_f32 v220, v220, v172
    v_mul_f32 v221, v221, v173
    v_mul_f32 v222, v222, v174
    v_mul_f32 v223, v223, v175
    v_mul_f32 v224, v224, v176
    v_mul_f32 v225, v225, v177
    v_mul_f32 v226, v226, v178
    v_mul_f32 v227, v227, v179
    s_setprio 1
    s_waitcnt lgkmcnt(0)
    v_mfma_f32_32x32x16_bf16 v[188:203], v[232:235], v[36:39], v[188:203]
    v_cvt_pk_bf16_f32 v228, v204, v205
    v_cvt_pk_bf16_f32 v229, v206, v207
    v_cvt_pk_bf16_f32 v230, v208, v209
    v_cvt_pk_bf16_f32 v231, v210, v211
    v_rcp_f32_e64 v212, v212
    v_mfma_f32_32x32x16_bf16 v[188:203], v[236:239], v[40:43], v[188:203]
    v_rcp_f32 v213, v213
    v_rcp_f32 v214, v214
    v_rcp_f32_e64 v215, v215
    v_mfma_f32_32x32x16_bf16 v[188:203], v[240:243], v[44:47], v[188:203]
    v_rcp_f32 v216, v216
    v_rcp_f32 v217, v217
    v_rcp_f32_e64 v218, v218
    v_mfma_f32_32x32x16_bf16 v[108:123], v[244:247], v[228:231], v[108:123]
    v_rcp_f32 v219, v219
    v_exp_f32 v220, v220
    v_exp_f32_e64 v221, v221
    v_mfma_f32_32x32x16_bf16 v[124:139], v[248:251], v[228:231], v[124:139]
    v_exp_f32 v222, v222
    v_exp_f32 v223, v223
    v_exp_f32_e64 v224, v224
    v_mfma_f32_32x32x16_bf16 v[140:155], v[252:255], v[228:231], v[140:155]
    v_exp_f32 v225, v225
    v_exp_f32 v226, v226
    v_exp_f32 v227, v227
    s_setprio 0
    ds_read_b64_tr_b16 v[232:233], v1 offset:33792
    ds_read_b64_tr_b16 v[234:235], v1 offset:34048
    ds_read_b64_tr_b16 v[236:237], v1 offset:34816
    ds_read_b64_tr_b16 v[238:239], v1 offset:35072
    ds_read_b64_tr_b16 v[240:241], v1 offset:35840
    ds_read_b64_tr_b16 v[242:243], v1 offset:36096
    ds_read_b64_tr_b16 v[244:245], v3 offset:21504
    ds_read_b64_tr_b16 v[246:247], v3 offset:22016
    ds_read_b64_tr_b16 v[248:249], v3 offset:22528
    ds_read_b64_tr_b16 v[250:251], v3 offset:23040
    ds_read_b64_tr_b16 v[252:253], v3 offset:23552
    ds_read_b64_tr_b16 v[254:255], v3 offset:24064
    ds_read_b128 v[156:159], v5 offset:768
    ds_read_b128 v[160:163], v5 offset:800
    s_waitcnt vmcnt(3)
    s_barrier
    v_mov_b32 v60, v84
    v_mov_b32 v61, v85
    v_mov_b32 v62, v86
    v_mov_b32 v63, v87
    v_mov_b32 v64, v88
    v_mov_b32 v65, v89
    v_mov_b32 v66, v90
    v_mov_b32 v67, v91
    v_mul_f32 v212, v212, v164
    v_mul_f32 v213, v213, v165
    v_mul_f32 v214, v214, v166
    v_mul_f32 v215, v215, v167
    v_mul_f32 v216, v216, v168
    v_mul_f32 v217, v217, v169
    v_mul_f32 v218, v218, v170
    v_mul_f32 v219, v219, v171
    v_add_f32 v220, 1.0, v220
    v_add_f32 v221, 1.0, v221
    v_add_f32 v222, 1.0, v222
    v_add_f32 v223, 1.0, v223
    v_add_f32 v224, 1.0, v224
    v_add_f32 v225, 1.0, v225
    v_add_f32 v226, 1.0, v226
    v_add_f32 v227, 1.0, v227
    v_fma_f32 v204, -v180, v180, s30
    v_fma_f32 v205, -v181, v181, s30
    v_fma_f32 v206, -v182, v182, s30
    v_fma_f32 v207, -v183, v183, s30
    v_fma_f32 v208, -v184, v184, s30
    v_fma_f32 v209, -v185, v185, s30
    v_fma_f32 v210, -v186, v186, s30
    v_fma_f32 v211, -v187, v187, s30
    v_mul_f32 v204, v204, v180
    v_mul_f32 v205, v205, v181
    v_mul_f32 v206, v206, v182
    v_mul_f32 v207, v207, v183
    v_mul_f32 v208, v208, v184
    v_mul_f32 v209, v209, v185
    v_mul_f32 v210, v210, v186
    v_mul_f32 v211, v211, v187
    s_setprio 1
    s_waitcnt lgkmcnt(0)
    v_mfma_f32_32x32x16_bf16 v[188:203], v[232:235], v[48:51], v[188:203]
    v_cvt_pk_bf16_f32 v228, v212, v213
    v_cvt_pk_bf16_f32 v229, v214, v215
    v_cvt_pk_bf16_f32 v230, v216, v217
    v_cvt_pk_bf16_f32 v231, v218, v219
    v_rcp_f32_e64 v220, v220
    v_mfma_f32_32x32x16_bf16 v[188:203], v[236:239], v[52:55], v[188:203]
    v_rcp_f32 v221, v221
    v_rcp_f32 v222, v222
    v_rcp_f32_e64 v223, v223
    v_mfma_f32_32x32x16_bf16 v[188:203], v[240:243], v[56:59], v[188:203]
    v_rcp_f32 v224, v224
    v_rcp_f32 v225, v225
    v_rcp_f32_e64 v226, v226
    v_mfma_f32_32x32x16_bf16 v[108:123], v[244:247], v[228:231], v[108:123]
    v_rcp_f32 v227, v227
    v_exp_f32 v204, v204
    v_exp_f32_e64 v205, v205
    v_mfma_f32_32x32x16_bf16 v[124:139], v[248:251], v[228:231], v[124:139]
    v_exp_f32 v206, v206
    v_exp_f32 v207, v207
    v_exp_f32_e64 v208, v208
    v_mfma_f32_32x32x16_bf16 v[140:155], v[252:255], v[228:231], v[140:155]
    v_exp_f32 v209, v209
    v_exp_f32 v210, v210
    v_exp_f32 v211, v211
    s_setprio 0
    ds_read_b64_tr_b16 v[232:233], v2 offset:0
    ds_read_b64_tr_b16 v[234:235], v2 offset:256
    ds_read_b64_tr_b16 v[236:237], v2 offset:1024
    ds_read_b64_tr_b16 v[238:239], v2 offset:1280
    ds_read_b64_tr_b16 v[240:241], v2 offset:2048
    ds_read_b64_tr_b16 v[242:243], v2 offset:2304
    ds_read_b64_tr_b16 v[244:245], v3 offset:24576
    ds_read_b64_tr_b16 v[246:247], v3 offset:25088
    ds_read_b64_tr_b16 v[248:249], v3 offset:25600
    ds_read_b64_tr_b16 v[250:251], v3 offset:26112
    ds_read_b64_tr_b16 v[252:253], v3 offset:26624
    ds_read_b64_tr_b16 v[254:255], v3 offset:27136
    ds_read_b128 v[164:167], v5 offset:832
    ds_read_b128 v[168:171], v5 offset:864
    buffer_load_dwordx4 v[84:87], v7, s[4:7], s27 offen offset:0
    v_mul_f32 v220, v220, v172
    v_mul_f32 v221, v221, v173
    v_mul_f32 v222, v222, v174
    v_mul_f32 v223, v223, v175
    v_mul_f32 v224, v224, v176
    v_mul_f32 v225, v225, v177
    v_mul_f32 v226, v226, v178
    v_mul_f32 v227, v227, v179
    v_add_f32 v204, 1.0, v204
    v_add_f32 v205, 1.0, v205
    v_add_f32 v206, 1.0, v206
    v_add_f32 v207, 1.0, v207
    v_add_f32 v208, 1.0, v208
    v_add_f32 v209, 1.0, v209
    v_add_f32 v210, 1.0, v210
    v_add_f32 v211, 1.0, v211
    v_fma_f32 v212, -v188, v188, s30
    v_fma_f32 v213, -v189, v189, s30
    v_fma_f32 v214, -v190, v190, s30
    v_fma_f32 v215, -v191, v191, s30
    v_fma_f32 v216, -v192, v192, s30
    v_fma_f32 v217, -v193, v193, s30
    v_fma_f32 v218, -v194, v194, s30
    v_fma_f32 v219, -v195, v195, s30
    v_mul_f32 v212, v212, v188
    v_mul_f32 v213, v213, v189
    v_mul_f32 v214, v214, v190
    v_mul_f32 v215, v215, v191
    v_mul_f32 v216, v216, v192
    v_mul_f32 v217, v217, v193
    v_mul_f32 v218, v218, v194
    v_mul_f32 v219, v219, v195
    s_setprio 1
    s_waitcnt lgkmcnt(0)
    v_mfma_f32_32x32x16_bf16 v[156:171], v[232:235], v[36:39], v[156:171]
    v_cvt_pk_bf16_f32 v228, v220, v221
    v_cvt_pk_bf16_f32 v229, v222, v223
    v_cvt_pk_bf16_f32 v230, v224, v225
    v_cvt_pk_bf16_f32 v231, v226, v227
    v_rcp_f32_e64 v204, v204
    v_mfma_f32_32x32x16_bf16 v[156:171], v[236:239], v[40:43], v[156:171]
    v_rcp_f32 v205, v205
    v_rcp_f32 v206, v206
    v_rcp_f32_e64 v207, v207
    v_mfma_f32_32x32x16_bf16 v[156:171], v[240:243], v[44:47], v[156:171]
    v_rcp_f32 v208, v208
    v_rcp_f32 v209, v209
    v_rcp_f32_e64 v210, v210
    v_mfma_f32_32x32x16_bf16 v[108:123], v[244:247], v[228:231], v[108:123]
    v_rcp_f32 v211, v211
    v_exp_f32 v212, v212
    v_exp_f32_e64 v213, v213
    v_mfma_f32_32x32x16_bf16 v[124:139], v[248:251], v[228:231], v[124:139]
    v_exp_f32 v214, v214
    v_exp_f32 v215, v215
    v_exp_f32_e64 v216, v216
    v_mfma_f32_32x32x16_bf16 v[140:155], v[252:255], v[228:231], v[140:155]
    v_exp_f32 v217, v217
    v_exp_f32 v218, v218
    v_exp_f32 v219, v219
    s_setprio 0
    ds_read_b64_tr_b16 v[232:233], v2 offset:3072
    ds_read_b64_tr_b16 v[234:235], v2 offset:3328
    ds_read_b64_tr_b16 v[236:237], v2 offset:4096
    ds_read_b64_tr_b16 v[238:239], v2 offset:4352
    ds_read_b64_tr_b16 v[240:241], v2 offset:5120
    ds_read_b64_tr_b16 v[242:243], v2 offset:5376
    ds_read_b64_tr_b16 v[244:245], v3 offset:27648
    ds_read_b64_tr_b16 v[246:247], v3 offset:28160
    ds_read_b64_tr_b16 v[248:249], v3 offset:28672
    ds_read_b64_tr_b16 v[250:251], v3 offset:29184
    ds_read_b64_tr_b16 v[252:253], v3 offset:29696
    ds_read_b64_tr_b16 v[254:255], v3 offset:30208
    ds_read_b128 v[172:175], v5 offset:896
    ds_read_b128 v[176:179], v5 offset:928
    v_mul_f32 v204, v204, v180
    v_mul_f32 v205, v205, v181
    v_mul_f32 v206, v206, v182
    v_mul_f32 v207, v207, v183
    v_mul_f32 v208, v208, v184
    v_mul_f32 v209, v209, v185
    v_mul_f32 v210, v210, v186
    v_mul_f32 v211, v211, v187
    v_add_f32 v212, 1.0, v212
    v_add_f32 v213, 1.0, v213
    v_add_f32 v214, 1.0, v214
    v_add_f32 v215, 1.0, v215
    v_add_f32 v216, 1.0, v216
    v_add_f32 v217, 1.0, v217
    v_add_f32 v218, 1.0, v218
    v_add_f32 v219, 1.0, v219
    v_fma_f32 v220, -v196, v196, s30
    v_fma_f32 v221, -v197, v197, s30
    v_fma_f32 v222, -v198, v198, s30
    v_fma_f32 v223, -v199, v199, s30
    v_fma_f32 v224, -v200, v200, s30
    v_fma_f32 v225, -v201, v201, s30
    v_fma_f32 v226, -v202, v202, s30
    v_fma_f32 v227, -v203, v203, s30
    v_mul_f32 v220, v220, v196
    v_mul_f32 v221, v221, v197
    v_mul_f32 v222, v222, v198
    v_mul_f32 v223, v223, v199
    v_mul_f32 v224, v224, v200
    v_mul_f32 v225, v225, v201
    v_mul_f32 v226, v226, v202
    v_mul_f32 v227, v227, v203
    s_setprio 1
    s_waitcnt lgkmcnt(0)
    v_mfma_f32_32x32x16_bf16 v[156:171], v[232:235], v[48:51], v[156:171]
    v_cvt_pk_bf16_f32 v228, v204, v205
    v_cvt_pk_bf16_f32 v229, v206, v207
    v_cvt_pk_bf16_f32 v230, v208, v209
    v_cvt_pk_bf16_f32 v231, v210, v211
    v_rcp_f32_e64 v212, v212
    v_mfma_f32_32x32x16_bf16 v[156:171], v[236:239], v[52:55], v[156:171]
    v_rcp_f32 v213, v213
    v_rcp_f32 v214, v214
    v_rcp_f32_e64 v215, v215
    v_mfma_f32_32x32x16_bf16 v[156:171], v[240:243], v[56:59], v[156:171]
    v_rcp_f32 v216, v216
    v_rcp_f32 v217, v217
    v_rcp_f32_e64 v218, v218
    v_mfma_f32_32x32x16_bf16 v[108:123], v[244:247], v[228:231], v[108:123]
    v_rcp_f32 v219, v219
    v_exp_f32 v220, v220
    v_exp_f32_e64 v221, v221
    v_mfma_f32_32x32x16_bf16 v[124:139], v[248:251], v[228:231], v[124:139]
    v_exp_f32 v222, v222
    v_exp_f32 v223, v223
    v_exp_f32_e64 v224, v224
    v_mfma_f32_32x32x16_bf16 v[140:155], v[252:255], v[228:231], v[140:155]
    v_exp_f32 v225, v225
    v_exp_f32 v226, v226
    v_exp_f32 v227, v227
    s_setprio 0
    ds_read_b64_tr_b16 v[232:233], v2 offset:6144
    ds_read_b64_tr_b16 v[234:235], v2 offset:6400
    ds_read_b64_tr_b16 v[236:237], v2 offset:7168
    ds_read_b64_tr_b16 v[238:239], v2 offset:7424
    ds_read_b64_tr_b16 v[240:241], v2 offset:8192
    ds_read_b64_tr_b16 v[242:243], v2 offset:8448
    ds_read_b64_tr_b16 v[244:245], v3 offset:30720
    ds_read_b64_tr_b16 v[246:247], v3 offset:31232
    ds_read_b64_tr_b16 v[248:249], v3 offset:31744
    ds_read_b64_tr_b16 v[250:251], v3 offset:32256
    ds_read_b64_tr_b16 v[252:253], v3 offset:32768
    ds_read_b64_tr_b16 v[254:255], v3 offset:33280
    ds_read_b128 v[180:183], v5 offset:960
    ds_read_b128 v[184:187], v5 offset:992
    v_mul_f32 v212, v212, v188
    v_mul_f32 v213, v213, v189
    v_mul_f32 v214, v214, v190
    v_mul_f32 v215, v215, v191
    v_mul_f32 v216, v216, v192
    v_mul_f32 v217, v217, v193
    v_mul_f32 v218, v218, v194
    v_mul_f32 v219, v219, v195
    v_add_f32 v220, 1.0, v220
    v_add_f32 v221, 1.0, v221
    v_add_f32 v222, 1.0, v222
    v_add_f32 v223, 1.0, v223
    v_add_f32 v224, 1.0, v224
    v_add_f32 v225, 1.0, v225
    v_add_f32 v226, 1.0, v226
    v_add_f32 v227, 1.0, v227
    v_fma_f32 v204, -v156, v156, s30
    v_fma_f32 v205, -v157, v157, s30
    v_fma_f32 v206, -v158, v158, s30
    v_fma_f32 v207, -v159, v159, s30
    v_fma_f32 v208, -v160, v160, s30
    v_fma_f32 v209, -v161, v161, s30
    v_fma_f32 v210, -v162, v162, s30
    v_fma_f32 v211, -v163, v163, s30
    v_mul_f32 v204, v204, v156
    v_mul_f32 v205, v205, v157
    v_mul_f32 v206, v206, v158
    v_mul_f32 v207, v207, v159
    v_mul_f32 v208, v208, v160
    v_mul_f32 v209, v209, v161
    v_mul_f32 v210, v210, v162
    v_mul_f32 v211, v211, v163
    s_setprio 1
    s_waitcnt lgkmcnt(0)
    v_mfma_f32_32x32x16_bf16 v[172:187], v[232:235], v[36:39], v[172:187]
    v_cvt_pk_bf16_f32 v228, v212, v213
    v_cvt_pk_bf16_f32 v229, v214, v215
    v_cvt_pk_bf16_f32 v230, v216, v217
    v_cvt_pk_bf16_f32 v231, v218, v219
    v_rcp_f32_e64 v220, v220
    v_mfma_f32_32x32x16_bf16 v[172:187], v[236:239], v[40:43], v[172:187]
    v_rcp_f32 v221, v221
    v_rcp_f32 v222, v222
    v_rcp_f32_e64 v223, v223
    v_mfma_f32_32x32x16_bf16 v[172:187], v[240:243], v[44:47], v[172:187]
    v_rcp_f32 v224, v224
    v_rcp_f32 v225, v225
    v_rcp_f32_e64 v226, v226
    v_mfma_f32_32x32x16_bf16 v[108:123], v[244:247], v[228:231], v[108:123]
    v_rcp_f32 v227, v227
    v_exp_f32 v204, v204
    v_exp_f32_e64 v205, v205
    v_mfma_f32_32x32x16_bf16 v[124:139], v[248:251], v[228:231], v[124:139]
    v_exp_f32 v206, v206
    v_exp_f32 v207, v207
    v_exp_f32_e64 v208, v208
    v_mfma_f32_32x32x16_bf16 v[140:155], v[252:255], v[228:231], v[140:155]
    v_exp_f32 v209, v209
    v_exp_f32 v210, v210
    v_exp_f32 v211, v211
    s_setprio 0
    ds_read_b64_tr_b16 v[232:233], v2 offset:9216
    ds_read_b64_tr_b16 v[234:235], v2 offset:9472
    ds_read_b64_tr_b16 v[236:237], v2 offset:10240
    ds_read_b64_tr_b16 v[238:239], v2 offset:10496
    ds_read_b64_tr_b16 v[240:241], v2 offset:11264
    ds_read_b64_tr_b16 v[242:243], v2 offset:11520
    ds_read_b64_tr_b16 v[244:245], v3 offset:33792
    ds_read_b64_tr_b16 v[246:247], v3 offset:34304
    ds_read_b64_tr_b16 v[248:249], v3 offset:34816
    ds_read_b64_tr_b16 v[250:251], v3 offset:35328
    ds_read_b64_tr_b16 v[252:253], v3 offset:35840
    ds_read_b64_tr_b16 v[254:255], v3 offset:36352
    ds_read_b128 v[188:191], v5 offset:1024
    ds_read_b128 v[192:195], v5 offset:1056
    v_mul_f32 v220, v220, v196
    v_mul_f32 v221, v221, v197
    v_mul_f32 v222, v222, v198
    v_mul_f32 v223, v223, v199
    v_mul_f32 v224, v224, v200
    v_mul_f32 v225, v225, v201
    v_mul_f32 v226, v226, v202
    v_mul_f32 v227, v227, v203
    v_add_f32 v204, 1.0, v204
    v_add_f32 v205, 1.0, v205
    v_add_f32 v206, 1.0, v206
    v_add_f32 v207, 1.0, v207
    v_add_f32 v208, 1.0, v208
    v_add_f32 v209, 1.0, v209
    v_add_f32 v210, 1.0, v210
    v_add_f32 v211, 1.0, v211
    v_fma_f32 v212, -v164, v164, s30
    v_fma_f32 v213, -v165, v165, s30
    v_fma_f32 v214, -v166, v166, s30
    v_fma_f32 v215, -v167, v167, s30
    v_fma_f32 v216, -v168, v168, s30
    v_fma_f32 v217, -v169, v169, s30
    v_fma_f32 v218, -v170, v170, s30
    v_fma_f32 v219, -v171, v171, s30
    v_mul_f32 v212, v212, v164
    v_mul_f32 v213, v213, v165
    v_mul_f32 v214, v214, v166
    v_mul_f32 v215, v215, v167
    v_mul_f32 v216, v216, v168
    v_mul_f32 v217, v217, v169
    v_mul_f32 v218, v218, v170
    v_mul_f32 v219, v219, v171
    s_setprio 1
    s_waitcnt lgkmcnt(0)
    v_mfma_f32_32x32x16_bf16 v[172:187], v[232:235], v[48:51], v[172:187]
    v_cvt_pk_bf16_f32 v228, v220, v221
    v_cvt_pk_bf16_f32 v229, v222, v223
    v_cvt_pk_bf16_f32 v230, v224, v225
    v_cvt_pk_bf16_f32 v231, v226, v227
    v_rcp_f32_e64 v204, v204
    v_mfma_f32_32x32x16_bf16 v[172:187], v[236:239], v[52:55], v[172:187]
    v_rcp_f32 v205, v205
    v_rcp_f32 v206, v206
    v_rcp_f32_e64 v207, v207
    v_mfma_f32_32x32x16_bf16 v[172:187], v[240:243], v[56:59], v[172:187]
    v_rcp_f32 v208, v208
    v_rcp_f32 v209, v209
    v_rcp_f32_e64 v210, v210
    v_mfma_f32_32x32x16_bf16 v[108:123], v[244:247], v[228:231], v[108:123]
    v_rcp_f32 v211, v211
    v_exp_f32 v212, v212
    v_exp_f32_e64 v213, v213
    v_mfma_f32_32x32x16_bf16 v[124:139], v[248:251], v[228:231], v[124:139]
    v_exp_f32 v214, v214
    v_exp_f32 v215, v215
    v_exp_f32_e64 v216, v216
    v_mfma_f32_32x32x16_bf16 v[140:155], v[252:255], v[228:231], v[140:155]
    v_exp_f32 v217, v217
    v_exp_f32 v218, v218
    v_exp_f32 v219, v219
    s_setprio 0
    ds_read_b64_tr_b16 v[232:233], v2 offset:12288
    ds_read_b64_tr_b16 v[234:235], v2 offset:12544
    ds_read_b64_tr_b16 v[236:237], v2 offset:13312
    ds_read_b64_tr_b16 v[238:239], v2 offset:13568
    ds_read_b64_tr_b16 v[240:241], v2 offset:14336
    ds_read_b64_tr_b16 v[242:243], v2 offset:14592
    ds_read_b64_tr_b16 v[244:245], v4 offset:0
    ds_read_b64_tr_b16 v[246:247], v4 offset:512
    ds_read_b64_tr_b16 v[248:249], v4 offset:1024
    ds_read_b64_tr_b16 v[250:251], v4 offset:1536
    ds_read_b64_tr_b16 v[252:253], v4 offset:2048
    ds_read_b64_tr_b16 v[254:255], v4 offset:2560
    ds_read_b128 v[196:199], v5 offset:1088
    ds_read_b128 v[200:203], v5 offset:1120
    buffer_load_dwordx4 v[88:91], v7, s[4:7], s27 offen offset:32
    v_mov_b32 v68, v92
    v_mov_b32 v69, v93
    v_mov_b32 v70, v94
    v_mov_b32 v71, v95
    v_mov_b32 v72, v96
    v_mov_b32 v73, v97
    v_mov_b32 v74, v98
    v_mov_b32 v75, v99
    v_mul_f32 v204, v204, v156
    v_mul_f32 v205, v205, v157
    v_mul_f32 v206, v206, v158
    v_mul_f32 v207, v207, v159
    v_mul_f32 v208, v208, v160
    v_mul_f32 v209, v209, v161
    v_mul_f32 v210, v210, v162
    v_mul_f32 v211, v211, v163
    v_add_f32 v212, 1.0, v212
    v_add_f32 v213, 1.0, v213
    v_add_f32 v214, 1.0, v214
    v_add_f32 v215, 1.0, v215
    v_add_f32 v216, 1.0, v216
    v_add_f32 v217, 1.0, v217
    v_add_f32 v218, 1.0, v218
    v_add_f32 v219, 1.0, v219
    v_fma_f32 v220, -v172, v172, s30
    v_fma_f32 v221, -v173, v173, s30
    v_fma_f32 v222, -v174, v174, s30
    v_fma_f32 v223, -v175, v175, s30
    v_fma_f32 v224, -v176, v176, s30
    v_fma_f32 v225, -v177, v177, s30
    v_fma_f32 v226, -v178, v178, s30
    v_fma_f32 v227, -v179, v179, s30
    v_mul_f32 v220, v220, v172
    v_mul_f32 v221, v221, v173
    v_mul_f32 v222, v222, v174
    v_mul_f32 v223, v223, v175
    v_mul_f32 v224, v224, v176
    v_mul_f32 v225, v225, v177
    v_mul_f32 v226, v226, v178
    v_mul_f32 v227, v227, v179
    s_setprio 1
    s_waitcnt lgkmcnt(0)
    v_mfma_f32_32x32x16_bf16 v[188:203], v[232:235], v[36:39], v[188:203]
    v_cvt_pk_bf16_f32 v228, v204, v205
    v_cvt_pk_bf16_f32 v229, v206, v207
    v_cvt_pk_bf16_f32 v230, v208, v209
    v_cvt_pk_bf16_f32 v231, v210, v211
    v_rcp_f32_e64 v212, v212
    v_mfma_f32_32x32x16_bf16 v[188:203], v[236:239], v[40:43], v[188:203]
    v_rcp_f32 v213, v213
    v_rcp_f32 v214, v214
    v_rcp_f32_e64 v215, v215
    v_mfma_f32_32x32x16_bf16 v[188:203], v[240:243], v[44:47], v[188:203]
    v_rcp_f32 v216, v216
    v_rcp_f32 v217, v217
    v_rcp_f32_e64 v218, v218
    v_mfma_f32_32x32x16_bf16 v[108:123], v[244:247], v[228:231], v[108:123]
    v_rcp_f32 v219, v219
    v_exp_f32 v220, v220
    v_exp_f32_e64 v221, v221
    v_mfma_f32_32x32x16_bf16 v[124:139], v[248:251], v[228:231], v[124:139]
    v_exp_f32 v222, v222
    v_exp_f32 v223, v223
    v_exp_f32_e64 v224, v224
    v_mfma_f32_32x32x16_bf16 v[140:155], v[252:255], v[228:231], v[140:155]
    v_exp_f32 v225, v225
    v_exp_f32 v226, v226
    v_exp_f32 v227, v227
    s_setprio 0
    ds_read_b64_tr_b16 v[232:233], v2 offset:15360
    ds_read_b64_tr_b16 v[234:235], v2 offset:15616
    ds_read_b64_tr_b16 v[236:237], v2 offset:16384
    ds_read_b64_tr_b16 v[238:239], v2 offset:16640
    ds_read_b64_tr_b16 v[240:241], v2 offset:17408
    ds_read_b64_tr_b16 v[242:243], v2 offset:17664
    ds_read_b64_tr_b16 v[244:245], v4 offset:3072
    ds_read_b64_tr_b16 v[246:247], v4 offset:3584
    ds_read_b64_tr_b16 v[248:249], v4 offset:4096
    ds_read_b64_tr_b16 v[250:251], v4 offset:4608
    ds_read_b64_tr_b16 v[252:253], v4 offset:5120
    ds_read_b64_tr_b16 v[254:255], v4 offset:5632
    ds_read_b128 v[156:159], v5 offset:1152
    ds_read_b128 v[160:163], v5 offset:1184
    buffer_load_dwordx4 v[92:95], v7, s[4:7], s27 offen offset:64
    v_mul_f32 v212, v212, v164
    v_mul_f32 v213, v213, v165
    v_mul_f32 v214, v214, v166
    v_mul_f32 v215, v215, v167
    v_mul_f32 v216, v216, v168
    v_mul_f32 v217, v217, v169
    v_mul_f32 v218, v218, v170
    v_mul_f32 v219, v219, v171
    v_add_f32 v220, 1.0, v220
    v_add_f32 v221, 1.0, v221
    v_add_f32 v222, 1.0, v222
    v_add_f32 v223, 1.0, v223
    v_add_f32 v224, 1.0, v224
    v_add_f32 v225, 1.0, v225
    v_add_f32 v226, 1.0, v226
    v_add_f32 v227, 1.0, v227
    v_fma_f32 v204, -v180, v180, s30
    v_fma_f32 v205, -v181, v181, s30
    v_fma_f32 v206, -v182, v182, s30
    v_fma_f32 v207, -v183, v183, s30
    v_fma_f32 v208, -v184, v184, s30
    v_fma_f32 v209, -v185, v185, s30
    v_fma_f32 v210, -v186, v186, s30
    v_fma_f32 v211, -v187, v187, s30
    v_mul_f32 v204, v204, v180
    v_mul_f32 v205, v205, v181
    v_mul_f32 v206, v206, v182
    v_mul_f32 v207, v207, v183
    v_mul_f32 v208, v208, v184
    v_mul_f32 v209, v209, v185
    v_mul_f32 v210, v210, v186
    v_mul_f32 v211, v211, v187
    s_setprio 1
    s_waitcnt lgkmcnt(0)
    v_mfma_f32_32x32x16_bf16 v[188:203], v[232:235], v[48:51], v[188:203]
    v_cvt_pk_bf16_f32 v228, v212, v213
    v_cvt_pk_bf16_f32 v229, v214, v215
    v_cvt_pk_bf16_f32 v230, v216, v217
    v_cvt_pk_bf16_f32 v231, v218, v219
    v_rcp_f32_e64 v220, v220
    v_mfma_f32_32x32x16_bf16 v[188:203], v[236:239], v[52:55], v[188:203]
    v_rcp_f32 v221, v221
    v_rcp_f32 v222, v222
    v_rcp_f32_e64 v223, v223
    v_mfma_f32_32x32x16_bf16 v[188:203], v[240:243], v[56:59], v[188:203]
    v_rcp_f32 v224, v224
    v_rcp_f32 v225, v225
    v_rcp_f32_e64 v226, v226
    v_mfma_f32_32x32x16_bf16 v[108:123], v[244:247], v[228:231], v[108:123]
    v_rcp_f32 v227, v227
    v_exp_f32 v204, v204
    v_exp_f32_e64 v205, v205
    v_mfma_f32_32x32x16_bf16 v[124:139], v[248:251], v[228:231], v[124:139]
    v_exp_f32 v206, v206
    v_exp_f32 v207, v207
    v_exp_f32_e64 v208, v208
    v_mfma_f32_32x32x16_bf16 v[140:155], v[252:255], v[228:231], v[140:155]
    v_exp_f32 v209, v209
    v_exp_f32 v210, v210
    v_exp_f32 v211, v211
    s_setprio 0
    ds_read_b64_tr_b16 v[232:233], v2 offset:18432
    ds_read_b64_tr_b16 v[234:235], v2 offset:18688
    ds_read_b64_tr_b16 v[236:237], v2 offset:19456
    ds_read_b64_tr_b16 v[238:239], v2 offset:19712
    ds_read_b64_tr_b16 v[240:241], v2 offset:20480
    ds_read_b64_tr_b16 v[242:243], v2 offset:20736
    ds_read_b64_tr_b16 v[244:245], v4 offset:6144
    ds_read_b64_tr_b16 v[246:247], v4 offset:6656
    ds_read_b64_tr_b16 v[248:249], v4 offset:7168
    ds_read_b64_tr_b16 v[250:251], v4 offset:7680
    ds_read_b64_tr_b16 v[252:253], v4 offset:8192
    ds_read_b64_tr_b16 v[254:255], v4 offset:8704
    ds_read_b128 v[164:167], v5 offset:1216
    ds_read_b128 v[168:171], v5 offset:1248
    v_mul_f32 v220, v220, v172
    v_mul_f32 v221, v221, v173
    v_mul_f32 v222, v222, v174
    v_mul_f32 v223, v223, v175
    v_mul_f32 v224, v224, v176
    v_mul_f32 v225, v225, v177
    v_mul_f32 v226, v226, v178
    v_mul_f32 v227, v227, v179
    v_add_f32 v204, 1.0, v204
    v_add_f32 v205, 1.0, v205
    v_add_f32 v206, 1.0, v206
    v_add_f32 v207, 1.0, v207
    v_add_f32 v208, 1.0, v208
    v_add_f32 v209, 1.0, v209
    v_add_f32 v210, 1.0, v210
    v_add_f32 v211, 1.0, v211
    v_fma_f32 v212, -v188, v188, s30
    v_fma_f32 v213, -v189, v189, s30
    v_fma_f32 v214, -v190, v190, s30
    v_fma_f32 v215, -v191, v191, s30
    v_fma_f32 v216, -v192, v192, s30
    v_fma_f32 v217, -v193, v193, s30
    v_fma_f32 v218, -v194, v194, s30
    v_fma_f32 v219, -v195, v195, s30
    v_mul_f32 v212, v212, v188
    v_mul_f32 v213, v213, v189
    v_mul_f32 v214, v214, v190
    v_mul_f32 v215, v215, v191
    v_mul_f32 v216, v216, v192
    v_mul_f32 v217, v217, v193
    v_mul_f32 v218, v218, v194
    v_mul_f32 v219, v219, v195
    s_setprio 1
    s_waitcnt lgkmcnt(0)
    v_mfma_f32_32x32x16_bf16 v[156:171], v[232:235], v[36:39], v[156:171]
    v_cvt_pk_bf16_f32 v228, v220, v221
    v_cvt_pk_bf16_f32 v229, v222, v223
    v_cvt_pk_bf16_f32 v230, v224, v225
    v_cvt_pk_bf16_f32 v231, v226, v227
    v_rcp_f32_e64 v204, v204
    v_mfma_f32_32x32x16_bf16 v[156:171], v[236:239], v[40:43], v[156:171]
    v_rcp_f32 v205, v205
    v_rcp_f32 v206, v206
    v_rcp_f32_e64 v207, v207
    v_mfma_f32_32x32x16_bf16 v[156:171], v[240:243], v[44:47], v[156:171]
    v_rcp_f32 v208, v208
    v_rcp_f32 v209, v209
    v_rcp_f32_e64 v210, v210
    v_mfma_f32_32x32x16_bf16 v[108:123], v[244:247], v[228:231], v[108:123]
    v_rcp_f32 v211, v211
    v_exp_f32 v212, v212
    v_exp_f32_e64 v213, v213
    v_mfma_f32_32x32x16_bf16 v[124:139], v[248:251], v[228:231], v[124:139]
    v_exp_f32 v214, v214
    v_exp_f32 v215, v215
    v_exp_f32_e64 v216, v216
    v_mfma_f32_32x32x16_bf16 v[140:155], v[252:255], v[228:231], v[140:155]
    v_exp_f32 v217, v217
    v_exp_f32 v218, v218
    v_exp_f32 v219, v219
    s_setprio 0
    ds_read_b64_tr_b16 v[232:233], v2 offset:21504
    ds_read_b64_tr_b16 v[234:235], v2 offset:21760
    ds_read_b64_tr_b16 v[236:237], v2 offset:22528
    ds_read_b64_tr_b16 v[238:239], v2 offset:22784
    ds_read_b64_tr_b16 v[240:241], v2 offset:23552
    ds_read_b64_tr_b16 v[242:243], v2 offset:23808
    ds_read_b64_tr_b16 v[244:245], v4 offset:9216
    ds_read_b64_tr_b16 v[246:247], v4 offset:9728
    ds_read_b64_tr_b16 v[248:249], v4 offset:10240
    ds_read_b64_tr_b16 v[250:251], v4 offset:10752
    ds_read_b64_tr_b16 v[252:253], v4 offset:11264
    ds_read_b64_tr_b16 v[254:255], v4 offset:11776
    ds_read_b128 v[172:175], v5 offset:1280
    ds_read_b128 v[176:179], v5 offset:1312
    v_mul_f32 v204, v204, v180
    v_mul_f32 v205, v205, v181
    v_mul_f32 v206, v206, v182
    v_mul_f32 v207, v207, v183
    v_mul_f32 v208, v208, v184
    v_mul_f32 v209, v209, v185
    v_mul_f32 v210, v210, v186
    v_mul_f32 v211, v211, v187
    v_add_f32 v212, 1.0, v212
    v_add_f32 v213, 1.0, v213
    v_add_f32 v214, 1.0, v214
    v_add_f32 v215, 1.0, v215
    v_add_f32 v216, 1.0, v216
    v_add_f32 v217, 1.0, v217
    v_add_f32 v218, 1.0, v218
    v_add_f32 v219, 1.0, v219
    v_fma_f32 v220, -v196, v196, s30
    v_fma_f32 v221, -v197, v197, s30
    v_fma_f32 v222, -v198, v198, s30
    v_fma_f32 v223, -v199, v199, s30
    v_fma_f32 v224, -v200, v200, s30
    v_fma_f32 v225, -v201, v201, s30
    v_fma_f32 v226, -v202, v202, s30
    v_fma_f32 v227, -v203, v203, s30
    v_mul_f32 v220, v220, v196
    v_mul_f32 v221, v221, v197
    v_mul_f32 v222, v222, v198
    v_mul_f32 v223, v223, v199
    v_mul_f32 v224, v224, v200
    v_mul_f32 v225, v225, v201
    v_mul_f32 v226, v226, v202
    v_mul_f32 v227, v227, v203
    s_setprio 1
    s_waitcnt lgkmcnt(0)
    v_mfma_f32_32x32x16_bf16 v[156:171], v[232:235], v[48:51], v[156:171]
    v_cvt_pk_bf16_f32 v228, v204, v205
    v_cvt_pk_bf16_f32 v229, v206, v207
    v_cvt_pk_bf16_f32 v230, v208, v209
    v_cvt_pk_bf16_f32 v231, v210, v211
    v_rcp_f32_e64 v212, v212
    v_mfma_f32_32x32x16_bf16 v[156:171], v[236:239], v[52:55], v[156:171]
    v_rcp_f32 v213, v213
    v_rcp_f32 v214, v214
    v_rcp_f32_e64 v215, v215
    v_mfma_f32_32x32x16_bf16 v[156:171], v[240:243], v[56:59], v[156:171]
    v_rcp_f32 v216, v216
    v_rcp_f32 v217, v217
    v_rcp_f32_e64 v218, v218
    v_mfma_f32_32x32x16_bf16 v[108:123], v[244:247], v[228:231], v[108:123]
    v_rcp_f32 v219, v219
    v_exp_f32 v220, v220
    v_exp_f32_e64 v221, v221
    v_mfma_f32_32x32x16_bf16 v[124:139], v[248:251], v[228:231], v[124:139]
    v_exp_f32 v222, v222
    v_exp_f32 v223, v223
    v_exp_f32_e64 v224, v224
    v_mfma_f32_32x32x16_bf16 v[140:155], v[252:255], v[228:231], v[140:155]
    v_exp_f32 v225, v225
    v_exp_f32 v226, v226
    v_exp_f32 v227, v227
    s_setprio 0
    ds_read_b64_tr_b16 v[232:233], v2 offset:24576
    ds_read_b64_tr_b16 v[234:235], v2 offset:24832
    ds_read_b64_tr_b16 v[236:237], v2 offset:25600
    ds_read_b64_tr_b16 v[238:239], v2 offset:25856
    ds_read_b64_tr_b16 v[240:241], v2 offset:26624
    ds_read_b64_tr_b16 v[242:243], v2 offset:26880
    ds_read_b64_tr_b16 v[244:245], v4 offset:12288
    ds_read_b64_tr_b16 v[246:247], v4 offset:12800
    ds_read_b64_tr_b16 v[248:249], v4 offset:13312
    ds_read_b64_tr_b16 v[250:251], v4 offset:13824
    ds_read_b64_tr_b16 v[252:253], v4 offset:14336
    ds_read_b64_tr_b16 v[254:255], v4 offset:14848
    ds_read_b128 v[180:183], v5 offset:1344
    ds_read_b128 v[184:187], v5 offset:1376
    v_mul_f32 v212, v212, v188
    v_mul_f32 v213, v213, v189
    v_mul_f32 v214, v214, v190
    v_mul_f32 v215, v215, v191
    v_mul_f32 v216, v216, v192
    v_mul_f32 v217, v217, v193
    v_mul_f32 v218, v218, v194
    v_mul_f32 v219, v219, v195
    v_add_f32 v220, 1.0, v220
    v_add_f32 v221, 1.0, v221
    v_add_f32 v222, 1.0, v222
    v_add_f32 v223, 1.0, v223
    v_add_f32 v224, 1.0, v224
    v_add_f32 v225, 1.0, v225
    v_add_f32 v226, 1.0, v226
    v_add_f32 v227, 1.0, v227
    v_fma_f32 v204, -v156, v156, s30
    v_fma_f32 v205, -v157, v157, s30
    v_fma_f32 v206, -v158, v158, s30
    v_fma_f32 v207, -v159, v159, s30
    v_fma_f32 v208, -v160, v160, s30
    v_fma_f32 v209, -v161, v161, s30
    v_fma_f32 v210, -v162, v162, s30
    v_fma_f32 v211, -v163, v163, s30
    v_mul_f32 v204, v204, v156
    v_mul_f32 v205, v205, v157
    v_mul_f32 v206, v206, v158
    v_mul_f32 v207, v207, v159
    v_mul_f32 v208, v208, v160
    v_mul_f32 v209, v209, v161
    v_mul_f32 v210, v210, v162
    v_mul_f32 v211, v211, v163
    s_setprio 1
    s_waitcnt lgkmcnt(0)
    v_mfma_f32_32x32x16_bf16 v[172:187], v[232:235], v[36:39], v[172:187]
    v_cvt_pk_bf16_f32 v228, v212, v213
    v_cvt_pk_bf16_f32 v229, v214, v215
    v_cvt_pk_bf16_f32 v230, v216, v217
    v_cvt_pk_bf16_f32 v231, v218, v219
    v_rcp_f32_e64 v220, v220
    v_mfma_f32_32x32x16_bf16 v[172:187], v[236:239], v[40:43], v[172:187]
    v_rcp_f32 v221, v221
    v_rcp_f32 v222, v222
    v_rcp_f32_e64 v223, v223
    v_mfma_f32_32x32x16_bf16 v[172:187], v[240:243], v[44:47], v[172:187]
    v_rcp_f32 v224, v224
    v_rcp_f32 v225, v225
    v_rcp_f32_e64 v226, v226
    v_mfma_f32_32x32x16_bf16 v[108:123], v[244:247], v[228:231], v[108:123]
    v_rcp_f32 v227, v227
    v_exp_f32 v204, v204
    v_exp_f32_e64 v205, v205
    v_mfma_f32_32x32x16_bf16 v[124:139], v[248:251], v[228:231], v[124:139]
    v_exp_f32 v206, v206
    v_exp_f32 v207, v207
    v_exp_f32_e64 v208, v208
    v_mfma_f32_32x32x16_bf16 v[140:155], v[252:255], v[228:231], v[140:155]
    v_exp_f32 v209, v209
    v_exp_f32 v210, v210
    v_exp_f32 v211, v211
    s_setprio 0
    ds_read_b64_tr_b16 v[232:233], v2 offset:27648
    ds_read_b64_tr_b16 v[234:235], v2 offset:27904
    ds_read_b64_tr_b16 v[236:237], v2 offset:28672
    ds_read_b64_tr_b16 v[238:239], v2 offset:28928
    ds_read_b64_tr_b16 v[240:241], v2 offset:29696
    ds_read_b64_tr_b16 v[242:243], v2 offset:29952
    ds_read_b64_tr_b16 v[244:245], v4 offset:15360
    ds_read_b64_tr_b16 v[246:247], v4 offset:15872
    ds_read_b64_tr_b16 v[248:249], v4 offset:16384
    ds_read_b64_tr_b16 v[250:251], v4 offset:16896
    ds_read_b64_tr_b16 v[252:253], v4 offset:17408
    ds_read_b64_tr_b16 v[254:255], v4 offset:17920
    ds_read_b128 v[188:191], v5 offset:1408
    ds_read_b128 v[192:195], v5 offset:1440
    buffer_load_dwordx4 v[96:99], v7, s[4:7], s27 offen offset:96
    v_mov_b32 v76, v100
    v_mov_b32 v77, v101
    v_mov_b32 v78, v102
    v_mov_b32 v79, v103
    v_mov_b32 v80, v104
    v_mov_b32 v81, v105
    v_mov_b32 v82, v106
    v_mov_b32 v83, v107
    v_mul_f32 v220, v220, v196
    v_mul_f32 v221, v221, v197
    v_mul_f32 v222, v222, v198
    v_mul_f32 v223, v223, v199
    v_mul_f32 v224, v224, v200
    v_mul_f32 v225, v225, v201
    v_mul_f32 v226, v226, v202
    v_mul_f32 v227, v227, v203
    v_add_f32 v204, 1.0, v204
    v_add_f32 v205, 1.0, v205
    v_add_f32 v206, 1.0, v206
    v_add_f32 v207, 1.0, v207
    v_add_f32 v208, 1.0, v208
    v_add_f32 v209, 1.0, v209
    v_add_f32 v210, 1.0, v210
    v_add_f32 v211, 1.0, v211
    v_fma_f32 v212, -v164, v164, s30
    v_fma_f32 v213, -v165, v165, s30
    v_fma_f32 v214, -v166, v166, s30
    v_fma_f32 v215, -v167, v167, s30
    v_fma_f32 v216, -v168, v168, s30
    v_fma_f32 v217, -v169, v169, s30
    v_fma_f32 v218, -v170, v170, s30
    v_fma_f32 v219, -v171, v171, s30
    v_mul_f32 v212, v212, v164
    v_mul_f32 v213, v213, v165
    v_mul_f32 v214, v214, v166
    v_mul_f32 v215, v215, v167
    v_mul_f32 v216, v216, v168
    v_mul_f32 v217, v217, v169
    v_mul_f32 v218, v218, v170
    v_mul_f32 v219, v219, v171
    s_setprio 1
    s_waitcnt lgkmcnt(0)
    v_mfma_f32_32x32x16_bf16 v[172:187], v[232:235], v[48:51], v[172:187]
    v_cvt_pk_bf16_f32 v228, v220, v221
    v_cvt_pk_bf16_f32 v229, v222, v223
    v_cvt_pk_bf16_f32 v230, v224, v225
    v_cvt_pk_bf16_f32 v231, v226, v227
    v_rcp_f32_e64 v204, v204
    v_mfma_f32_32x32x16_bf16 v[172:187], v[236:239], v[52:55], v[172:187]
    v_rcp_f32 v205, v205
    v_rcp_f32 v206, v206
    v_rcp_f32_e64 v207, v207
    v_mfma_f32_32x32x16_bf16 v[172:187], v[240:243], v[56:59], v[172:187]
    v_rcp_f32 v208, v208
    v_rcp_f32 v209, v209
    v_rcp_f32_e64 v210, v210
    v_mfma_f32_32x32x16_bf16 v[108:123], v[244:247], v[228:231], v[108:123]
    v_rcp_f32 v211, v211
    v_exp_f32 v212, v212
    v_exp_f32_e64 v213, v213
    v_mfma_f32_32x32x16_bf16 v[124:139], v[248:251], v[228:231], v[124:139]
    v_exp_f32 v214, v214
    v_exp_f32 v215, v215
    v_exp_f32_e64 v216, v216
    v_mfma_f32_32x32x16_bf16 v[140:155], v[252:255], v[228:231], v[140:155]
    v_exp_f32 v217, v217
    v_exp_f32 v218, v218
    v_exp_f32 v219, v219
    s_setprio 0
    ds_read_b64_tr_b16 v[232:233], v2 offset:30720
    ds_read_b64_tr_b16 v[234:235], v2 offset:30976
    ds_read_b64_tr_b16 v[236:237], v2 offset:31744
    ds_read_b64_tr_b16 v[238:239], v2 offset:32000
    ds_read_b64_tr_b16 v[240:241], v2 offset:32768
    ds_read_b64_tr_b16 v[242:243], v2 offset:33024
    ds_read_b64_tr_b16 v[244:245], v4 offset:18432
    ds_read_b64_tr_b16 v[246:247], v4 offset:18944
    ds_read_b64_tr_b16 v[248:249], v4 offset:19456
    ds_read_b64_tr_b16 v[250:251], v4 offset:19968
    ds_read_b64_tr_b16 v[252:253], v4 offset:20480
    ds_read_b64_tr_b16 v[254:255], v4 offset:20992
    ds_read_b128 v[196:199], v5 offset:1472
    ds_read_b128 v[200:203], v5 offset:1504
    buffer_load_dwordx4 v[100:103], v7, s[4:7], s27 offen offset:128
    v_mul_f32 v204, v204, v156
    v_mul_f32 v205, v205, v157
    v_mul_f32 v206, v206, v158
    v_mul_f32 v207, v207, v159
    v_mul_f32 v208, v208, v160
    v_mul_f32 v209, v209, v161
    v_mul_f32 v210, v210, v162
    v_mul_f32 v211, v211, v163
    v_add_f32 v212, 1.0, v212
    v_add_f32 v213, 1.0, v213
    v_add_f32 v214, 1.0, v214
    v_add_f32 v215, 1.0, v215
    v_add_f32 v216, 1.0, v216
    v_add_f32 v217, 1.0, v217
    v_add_f32 v218, 1.0, v218
    v_add_f32 v219, 1.0, v219
    v_fma_f32 v220, -v172, v172, s30
    v_fma_f32 v221, -v173, v173, s30
    v_fma_f32 v222, -v174, v174, s30
    v_fma_f32 v223, -v175, v175, s30
    v_fma_f32 v224, -v176, v176, s30
    v_fma_f32 v225, -v177, v177, s30
    v_fma_f32 v226, -v178, v178, s30
    v_fma_f32 v227, -v179, v179, s30
    v_mul_f32 v220, v220, v172
    v_mul_f32 v221, v221, v173
    v_mul_f32 v222, v222, v174
    v_mul_f32 v223, v223, v175
    v_mul_f32 v224, v224, v176
    v_mul_f32 v225, v225, v177
    v_mul_f32 v226, v226, v178
    v_mul_f32 v227, v227, v179
    s_setprio 1
    s_waitcnt lgkmcnt(0)
    v_mfma_f32_32x32x16_bf16 v[188:203], v[232:235], v[36:39], v[188:203]
    v_cvt_pk_bf16_f32 v228, v204, v205
    v_cvt_pk_bf16_f32 v229, v206, v207
    v_cvt_pk_bf16_f32 v230, v208, v209
    v_cvt_pk_bf16_f32 v231, v210, v211
    v_rcp_f32_e64 v212, v212
    v_mfma_f32_32x32x16_bf16 v[188:203], v[236:239], v[40:43], v[188:203]
    v_rcp_f32 v213, v213
    v_rcp_f32 v214, v214
    v_rcp_f32_e64 v215, v215
    v_mfma_f32_32x32x16_bf16 v[188:203], v[240:243], v[44:47], v[188:203]
    v_rcp_f32 v216, v216
    v_rcp_f32 v217, v217
    v_rcp_f32_e64 v218, v218
    v_mfma_f32_32x32x16_bf16 v[108:123], v[244:247], v[228:231], v[108:123]
    v_rcp_f32 v219, v219
    v_exp_f32 v220, v220
    v_exp_f32_e64 v221, v221
    v_mfma_f32_32x32x16_bf16 v[124:139], v[248:251], v[228:231], v[124:139]
    v_exp_f32 v222, v222
    v_exp_f32 v223, v223
    v_exp_f32_e64 v224, v224
    v_mfma_f32_32x32x16_bf16 v[140:155], v[252:255], v[228:231], v[140:155]
    v_exp_f32 v225, v225
    v_exp_f32 v226, v226
    v_exp_f32 v227, v227
    s_setprio 0
    ds_read_b64_tr_b16 v[232:233], v2 offset:33792
    ds_read_b64_tr_b16 v[234:235], v2 offset:34048
    ds_read_b64_tr_b16 v[236:237], v2 offset:34816
    ds_read_b64_tr_b16 v[238:239], v2 offset:35072
    ds_read_b64_tr_b16 v[240:241], v2 offset:35840
    ds_read_b64_tr_b16 v[242:243], v2 offset:36096
    ds_read_b64_tr_b16 v[244:245], v4 offset:21504
    ds_read_b64_tr_b16 v[246:247], v4 offset:22016
    ds_read_b64_tr_b16 v[248:249], v4 offset:22528
    ds_read_b64_tr_b16 v[250:251], v4 offset:23040
    ds_read_b64_tr_b16 v[252:253], v4 offset:23552
    ds_read_b64_tr_b16 v[254:255], v4 offset:24064
    v_mul_f32 v212, v212, v164
    v_mul_f32 v213, v213, v165
    v_mul_f32 v214, v214, v166
    v_mul_f32 v215, v215, v167
    v_mul_f32 v216, v216, v168
    v_mul_f32 v217, v217, v169
    v_mul_f32 v218, v218, v170
    v_mul_f32 v219, v219, v171
    v_add_f32 v220, 1.0, v220
    v_add_f32 v221, 1.0, v221
    v_add_f32 v222, 1.0, v222
    v_add_f32 v223, 1.0, v223
    v_add_f32 v224, 1.0, v224
    v_add_f32 v225, 1.0, v225
    v_add_f32 v226, 1.0, v226
    v_add_f32 v227, 1.0, v227
    v_fma_f32 v204, -v180, v180, s30
    v_fma_f32 v205, -v181, v181, s30
    v_fma_f32 v206, -v182, v182, s30
    v_fma_f32 v207, -v183, v183, s30
    v_fma_f32 v208, -v184, v184, s30
    v_fma_f32 v209, -v185, v185, s30
    v_fma_f32 v210, -v186, v186, s30
    v_fma_f32 v211, -v187, v187, s30
    v_mul_f32 v204, v204, v180
    v_mul_f32 v205, v205, v181
    v_mul_f32 v206, v206, v182
    v_mul_f32 v207, v207, v183
    v_mul_f32 v208, v208, v184
    v_mul_f32 v209, v209, v185
    v_mul_f32 v210, v210, v186
    v_mul_f32 v211, v211, v187
    s_setprio 1
    s_waitcnt lgkmcnt(0)
    v_mfma_f32_32x32x16_bf16 v[188:203], v[232:235], v[48:51], v[188:203]
    v_cvt_pk_bf16_f32 v228, v212, v213
    v_cvt_pk_bf16_f32 v229, v214, v215
    v_cvt_pk_bf16_f32 v230, v216, v217
    v_cvt_pk_bf16_f32 v231, v218, v219
    v_rcp_f32_e64 v220, v220
    v_mfma_f32_32x32x16_bf16 v[188:203], v[236:239], v[52:55], v[188:203]
    v_rcp_f32 v221, v221
    v_rcp_f32 v222, v222
    v_rcp_f32_e64 v223, v223
    v_mfma_f32_32x32x16_bf16 v[188:203], v[240:243], v[56:59], v[188:203]
    v_rcp_f32 v224, v224
    v_rcp_f32 v225, v225
    v_rcp_f32_e64 v226, v226
    v_mfma_f32_32x32x16_bf16 v[108:123], v[244:247], v[228:231], v[108:123]
    v_rcp_f32 v227, v227
    v_exp_f32 v204, v204
    v_exp_f32_e64 v205, v205
    v_mfma_f32_32x32x16_bf16 v[124:139], v[248:251], v[228:231], v[124:139]
    v_exp_f32 v206, v206
    v_exp_f32 v207, v207
    v_exp_f32_e64 v208, v208
    v_mfma_f32_32x32x16_bf16 v[140:155], v[252:255], v[228:231], v[140:155]
    v_exp_f32 v209, v209
    v_exp_f32 v210, v210
    v_exp_f32 v211, v211
    s_setprio 0
    ds_read_b64_tr_b16 v[244:245], v4 offset:24576
    ds_read_b64_tr_b16 v[246:247], v4 offset:25088
    ds_read_b64_tr_b16 v[248:249], v4 offset:25600
    ds_read_b64_tr_b16 v[250:251], v4 offset:26112
    ds_read_b64_tr_b16 v[252:253], v4 offset:26624
    ds_read_b64_tr_b16 v[254:255], v4 offset:27136
    v_mul_f32 v220, v220, v172
    v_mul_f32 v221, v221, v173
    v_mul_f32 v222, v222, v174
    v_mul_f32 v223, v223, v175
    v_mul_f32 v224, v224, v176
    v_mul_f32 v225, v225, v177
    v_mul_f32 v226, v226, v178
    v_mul_f32 v227, v227, v179
    v_add_f32 v204, 1.0, v204
    v_add_f32 v205, 1.0, v205
    v_add_f32 v206, 1.0, v206
    v_add_f32 v207, 1.0, v207
    v_add_f32 v208, 1.0, v208
    v_add_f32 v209, 1.0, v209
    v_add_f32 v210, 1.0, v210
    v_add_f32 v211, 1.0, v211
    v_fma_f32 v212, -v188, v188, s30
    v_fma_f32 v213, -v189, v189, s30
    v_fma_f32 v214, -v190, v190, s30
    v_fma_f32 v215, -v191, v191, s30
    v_fma_f32 v216, -v192, v192, s30
    v_fma_f32 v217, -v193, v193, s30
    v_fma_f32 v218, -v194, v194, s30
    v_fma_f32 v219, -v195, v195, s30
    v_mul_f32 v212, v212, v188
    v_mul_f32 v213, v213, v189
    v_mul_f32 v214, v214, v190
    v_mul_f32 v215, v215, v191
    v_mul_f32 v216, v216, v192
    v_mul_f32 v217, v217, v193
    v_mul_f32 v218, v218, v194
    v_mul_f32 v219, v219, v195
    s_setprio 1
    s_waitcnt lgkmcnt(0)
    v_cvt_pk_bf16_f32 v228, v220, v221
    v_cvt_pk_bf16_f32 v229, v222, v223
    v_cvt_pk_bf16_f32 v230, v224, v225
    v_cvt_pk_bf16_f32 v231, v226, v227
    s_nop 1
    v_mfma_f32_32x32x16_bf16 v[108:123], v[244:247], v[228:231], v[108:123]
    v_rcp_f32 v204, v204
    v_rcp_f32 v205, v205
    v_rcp_f32 v206, v206
    v_rcp_f32 v207, v207
    v_rcp_f32 v208, v208
    v_rcp_f32_e64 v209, v209
    v_mfma_f32_32x32x16_bf16 v[124:139], v[248:251], v[228:231], v[124:139]
    v_rcp_f32 v210, v210
    v_rcp_f32 v211, v211
    v_exp_f32 v212, v212
    v_exp_f32 v213, v213
    v_exp_f32_e64 v214, v214
    v_mfma_f32_32x32x16_bf16 v[140:155], v[252:255], v[228:231], v[140:155]
    v_exp_f32 v215, v215
    v_exp_f32 v216, v216
    v_exp_f32 v217, v217
    v_exp_f32 v218, v218
    v_exp_f32 v219, v219
    s_setprio 0
    ds_read_b64_tr_b16 v[244:245], v4 offset:27648
    ds_read_b64_tr_b16 v[246:247], v4 offset:28160
    ds_read_b64_tr_b16 v[248:249], v4 offset:28672
    ds_read_b64_tr_b16 v[250:251], v4 offset:29184
    ds_read_b64_tr_b16 v[252:253], v4 offset:29696
    ds_read_b64_tr_b16 v[254:255], v4 offset:30208
    v_mul_f32 v204, v204, v180
    v_mul_f32 v205, v205, v181
    v_mul_f32 v206, v206, v182
    v_mul_f32 v207, v207, v183
    v_mul_f32 v208, v208, v184
    v_mul_f32 v209, v209, v185
    v_mul_f32 v210, v210, v186
    v_mul_f32 v211, v211, v187
    v_add_f32 v212, 1.0, v212
    v_add_f32 v213, 1.0, v213
    v_add_f32 v214, 1.0, v214
    v_add_f32 v215, 1.0, v215
    v_add_f32 v216, 1.0, v216
    v_add_f32 v217, 1.0, v217
    v_add_f32 v218, 1.0, v218
    v_add_f32 v219, 1.0, v219
    v_fma_f32 v220, -v196, v196, s30
    v_fma_f32 v221, -v197, v197, s30
    v_fma_f32 v222, -v198, v198, s30
    v_fma_f32 v223, -v199, v199, s30
    v_fma_f32 v224, -v200, v200, s30
    v_fma_f32 v225, -v201, v201, s30
    v_fma_f32 v226, -v202, v202, s30
    v_fma_f32 v227, -v203, v203, s30
    v_mul_f32 v220, v220, v196
    v_mul_f32 v221, v221, v197
    v_mul_f32 v222, v222, v198
    v_mul_f32 v223, v223, v199
    v_mul_f32 v224, v224, v200
    v_mul_f32 v225, v225, v201
    v_mul_f32 v226, v226, v202
    v_mul_f32 v227, v227, v203
    s_setprio 1
    s_waitcnt lgkmcnt(0)
    v_cvt_pk_bf16_f32 v228, v204, v205
    v_cvt_pk_bf16_f32 v229, v206, v207
    v_cvt_pk_bf16_f32 v230, v208, v209
    v_cvt_pk_bf16_f32 v231, v210, v211
    s_nop 1
    v_mfma_f32_32x32x16_bf16 v[108:123], v[244:247], v[228:231], v[108:123]
    v_rcp_f32 v212, v212
    v_rcp_f32 v213, v213
    v_rcp_f32 v214, v214
    v_rcp_f32 v215, v215
    v_rcp_f32 v216, v216
    v_rcp_f32_e64 v217, v217
    v_mfma_f32_32x32x16_bf16 v[124:139], v[248:251], v[228:231], v[124:139]
    v_rcp_f32 v218, v218
    v_rcp_f32 v219, v219
    v_exp_f32 v220, v220
    v_exp_f32 v221, v221
    v_exp_f32_e64 v222, v222
    v_mfma_f32_32x32x16_bf16 v[140:155], v[252:255], v[228:231], v[140:155]
    v_exp_f32 v223, v223
    v_exp_f32 v224, v224
    v_exp_f32 v225, v225
    v_exp_f32 v226, v226
    v_exp_f32 v227, v227
    s_setprio 0
    ds_read_b64_tr_b16 v[244:245], v4 offset:30720
    ds_read_b64_tr_b16 v[246:247], v4 offset:31232
    ds_read_b64_tr_b16 v[248:249], v4 offset:31744
    ds_read_b64_tr_b16 v[250:251], v4 offset:32256
    ds_read_b64_tr_b16 v[252:253], v4 offset:32768
    ds_read_b64_tr_b16 v[254:255], v4 offset:33280
    buffer_load_dwordx4 v[104:107], v7, s[4:7], s27 offen offset:160
    v_mul_f32 v212, v212, v188
    v_mul_f32 v213, v213, v189
    v_mul_f32 v214, v214, v190
    v_mul_f32 v215, v215, v191
    v_mul_f32 v216, v216, v192
    v_mul_f32 v217, v217, v193
    v_mul_f32 v218, v218, v194
    v_mul_f32 v219, v219, v195
    v_add_f32 v220, 1.0, v220
    v_add_f32 v221, 1.0, v221
    v_add_f32 v222, 1.0, v222
    v_add_f32 v223, 1.0, v223
    v_add_f32 v224, 1.0, v224
    v_add_f32 v225, 1.0, v225
    v_add_f32 v226, 1.0, v226
    v_add_f32 v227, 1.0, v227
    s_setprio 1
    s_waitcnt lgkmcnt(0)
    v_cvt_pk_bf16_f32 v228, v212, v213
    v_cvt_pk_bf16_f32 v229, v214, v215
    v_cvt_pk_bf16_f32 v230, v216, v217
    v_cvt_pk_bf16_f32 v231, v218, v219
    s_nop 1
    v_mfma_f32_32x32x16_bf16 v[108:123], v[244:247], v[228:231], v[108:123]
    v_rcp_f32 v220, v220
    v_rcp_f32 v221, v221
    v_rcp_f32 v222, v222
    v_mfma_f32_32x32x16_bf16 v[124:139], v[248:251], v[228:231], v[124:139]
    v_rcp_f32 v223, v223
    v_rcp_f32 v224, v224
    v_rcp_f32_e64 v225, v225
    v_mfma_f32_32x32x16_bf16 v[140:155], v[252:255], v[228:231], v[140:155]
    v_rcp_f32_e64 v226, v226
    v_rcp_f32 v227, v227
    s_setprio 0
    ds_read_b64_tr_b16 v[244:245], v4 offset:33792
    ds_read_b64_tr_b16 v[246:247], v4 offset:34304
    ds_read_b64_tr_b16 v[248:249], v4 offset:34816
    ds_read_b64_tr_b16 v[250:251], v4 offset:35328
    ds_read_b64_tr_b16 v[252:253], v4 offset:35840
    ds_read_b64_tr_b16 v[254:255], v4 offset:36352
    ds_read_b128 v[232:235], v5 offset:2304
    ds_read_b128 v[236:239], v5 offset:2336
    ds_read_b128 v[240:243], v5 offset:2368
    v_mul_f32 v220, v220, v196
    v_mul_f32 v221, v221, v197
    v_mul_f32 v222, v222, v198
    v_mul_f32 v223, v223, v199
    v_mul_f32 v224, v224, v200
    v_mul_f32 v225, v225, v201
    v_mul_f32 v226, v226, v202
    v_mul_f32 v227, v227, v203
    s_setprio 1
    s_waitcnt lgkmcnt(0)
    v_cvt_pk_bf16_f32 v228, v220, v221
    v_cvt_pk_bf16_f32 v229, v222, v223
    v_cvt_pk_bf16_f32 v230, v224, v225
    v_cvt_pk_bf16_f32 v231, v226, v227
    s_nop 1
    v_mfma_f32_32x32x16_bf16 v[108:123], v[244:247], v[228:231], v[108:123]
    v_mfma_f32_32x32x16_bf16 v[124:139], v[248:251], v[228:231], v[124:139]
    v_mfma_f32_32x32x16_bf16 v[140:155], v[252:255], v[228:231], v[140:155]
    s_setprio 0
    s_mov_b32 s28, s29
    s_mov_b32 s10, 50331648
    s_sub_u32 s26, s26, 1
    s_cmp_lg_u32 s26, 0
    s_cbranch_scc1 L_loopA_pre
    s_waitcnt vmcnt(0) lgkmcnt(0)
    s_mul_i32 s68, s24, 6144
    s_add_u32 s69, s68, 43008
    s_cmp_ge_u32 s24, 5
    s_cselect_b32 s68, s69, s68
    v_add_u32 v1, s68, v7
    v_subrev_u32 v2, 150016, v6
    v_add_u32 v3, s68, v2
    v_add_u32 v4, 0x1000, v2
    ds_read_b128 v[156:159], v5 offset:1920
    ds_read_b128 v[160:163], v5 offset:1952
    ds_read_b128 v[164:167], v5 offset:1984
    ds_read_b128 v[168:171], v5 offset:2016
    ds_read_b128 v[172:175], v5 offset:2048
    ds_read_b128 v[176:179], v5 offset:2080
    ds_read_b128 v[180:183], v5 offset:2112
    ds_read_b128 v[184:187], v5 offset:2144
    ds_read_b128 v[188:191], v5 offset:2176
    ds_read_b128 v[192:195], v5 offset:2208
    ds_read_b128 v[196:199], v5 offset:2240
    ds_read_b128 v[200:203], v5 offset:2272
    s_waitcnt lgkmcnt(8)
    v_mfma_f32_32x32x16_bf16 v[156:171], v[12:15], v[60:63], v[156:171]
    v_mfma_f32_32x32x16_bf16 v[156:171], v[16:19], v[64:67], v[156:171]
    ds_read_b128 v[36:39], v5 offset:1536
    ds_read_b128 v[40:43], v5 offset:1568
    ds_read_b128 v[44:47], v5 offset:1600
    ds_read_b128 v[48:51], v5 offset:1632
    s_waitcnt lgkmcnt(8)
    v_mfma_f32_32x32x16_bf16 v[172:187], v[12:15], v[68:71], v[172:187]
    v_mfma_f32_32x32x16_bf16 v[172:187], v[16:19], v[72:75], v[172:187]
    ds_read_b128 v[204:207], v5 offset:1664
    ds_read_b128 v[208:211], v5 offset:1696
    ds_read_b128 v[212:215], v5 offset:1728
    ds_read_b128 v[216:219], v5 offset:1760
    s_waitcnt lgkmcnt(8)
    v_mfma_f32_32x32x16_bf16 v[188:203], v[12:15], v[76:79], v[188:203]
    v_mfma_f32_32x32x16_bf16 v[188:203], v[16:19], v[80:83], v[188:203]
    ds_read_b128 v[20:23], v5 offset:1792
    ds_read_b128 v[24:27], v5 offset:1824
    ds_read_b128 v[28:31], v5 offset:1856
    ds_read_b128 v[32:35], v5 offset:1888
    s_waitcnt lgkmcnt(11)
    v_fma_f32 v108, v108, v36, v156
    v_fma_f32 v109, v109, v37, v157
    v_fma_f32 v110, v110, v38, v158
    v_fma_f32 v111, v111, v39, v159
    s_waitcnt lgkmcnt(10)
    v_fma_f32 v112, v112, v40, v160
    v_fma_f32 v113, v113, v41, v161
    v_fma_f32 v114, v114, v42, v162
    v_fma_f32 v115, v115, v43, v163
    s_waitcnt lgkmcnt(9)
    v_fma_f32 v116, v116, v44, v164
    v_fma_f32 v117, v117, v45, v165
    v_fma_f32 v118, v118, v46, v166
    v_fma_f32 v119, v119, v47, v167
    s_waitcnt lgkmcnt(8)
    v_fma_f32 v120, v120, v48, v168
    v_fma_f32 v121, v121, v49, v169
    v_fma_f32 v122, v122, v50, v170
    v_fma_f32 v123, v123, v51, v171
    v_cvt_pk_bf16_f32 v108, v108, v109
    v_cvt_pk_bf16_f32 v109, v110, v111
    v_cvt_pk_bf16_f32 v110, v112, v113
    v_cvt_pk_bf16_f32 v111, v114, v115
    v_cvt_pk_bf16_f32 v112, v116, v117
    v_cvt_pk_bf16_f32 v113, v118, v119
    v_cvt_pk_bf16_f32 v114, v120, v121
    v_cvt_pk_bf16_f32 v115, v122, v123
    ds_write_b128 v1, v[108:111] offset:0
    ds_write_b128 v1, v[112:115] offset:32
    s_waitcnt lgkmcnt(9)
    v_fma_f32 v124, v124, v204, v172
    v_fma_f32 v125, v125, v205, v173
    v_fma_f32 v126, v126, v206, v174
    v_fma_f32 v127, v127, v207, v175
    s_waitcnt lgkmcnt(8)
    v_fma_f32 v128, v128, v208, v176
    v_fma_f32 v129, v129, v209, v177
    v_fma_f32 v130, v130, v210, v178
    v_fma_f32 v131, v131, v211, v179
    s_waitcnt lgkmcnt(7)
    v_fma_f32 v132, v132, v212, v180
    v_fma_f32 v133, v133, v213, v181
    v_fma_f32 v134, v134, v214, v182
    v_fma_f32 v135, v135, v215, v183
    s_waitcnt lgkmcnt(6)
    v_fma_f32 v136, v136, v216, v184
    v_fma_f32 v137, v137, v217, v185
    v_fma_f32 v138, v138, v218, v186
    v_fma_f32 v139, v139, v219, v187
    v_cvt_pk_bf16_f32 v124, v124, v125
    v_cvt_pk_bf16_f32 v125, v126, v127
    v_cvt_pk_bf16_f32 v126, v128, v129
    v_cvt_pk_bf16_f32 v127, v130, v131
    v_cvt_pk_bf16_f32 v128, v132, v133
    v_cvt_pk_bf16_f32 v129, v134, v135
    v_cvt_pk_bf16_f32 v130, v136, v137
    v_cvt_pk_bf16_f32 v131, v138, v139
    ds_write_b128 v1, v[124:127] offset:64
    ds_write_b128 v1, v[128:131] offset:96
    s_waitcnt lgkmcnt(7)
    v_fma_f32 v140, v140, v20, v188
    v_fma_f32 v141, v141, v21, v189
    v_fma_f32 v142, v142, v22, v190
    v_fma_f32 v143, v143, v23, v191
    s_waitcnt lgkmcnt(6)
    v_fma_f32 v144, v144, v24, v192
    v_fma_f32 v145, v145, v25, v193
    v_fma_f32 v146, v146, v26, v194
    v_fma_f32 v147, v147, v27, v195
    s_waitcnt lgkmcnt(5)
    v_fma_f32 v148, v148, v28, v196
    v_fma_f32 v149, v149, v29, v197
    v_fma_f32 v150, v150, v30, v198
    v_fma_f32 v151, v151, v31, v199
    s_waitcnt lgkmcnt(4)
    v_fma_f32 v152, v152, v32, v200
    v_fma_f32 v153, v153, v33, v201
    v_fma_f32 v154, v154, v34, v202
    v_fma_f32 v155, v155, v35, v203
    v_cvt_pk_bf16_f32 v140, v140, v141
    v_cvt_pk_bf16_f32 v141, v142, v143
    v_cvt_pk_bf16_f32 v142, v144, v145
    v_cvt_pk_bf16_f32 v143, v146, v147
    v_cvt_pk_bf16_f32 v144, v148, v149
    v_cvt_pk_bf16_f32 v145, v150, v151
    v_cvt_pk_bf16_f32 v146, v152, v153
    v_cvt_pk_bf16_f32 v147, v154, v155
    ds_write_b128 v1, v[140:143] offset:128
    ds_write_b128 v1, v[144:147] offset:160
    s_waitcnt lgkmcnt(0)
    ds_read_b128 v[84:87], v3 offset:0
    ds_read_b128 v[88:91], v3 offset:1024
    ds_read_b128 v[92:95], v3 offset:2048
    ds_read_b128 v[96:99], v3 offset:3072
    ds_read_b128 v[100:103], v3 offset:4096
    ds_read_b128 v[104:107], v3 offset:5120
    s_waitcnt lgkmcnt(5)
    buffer_store_dwordx4 v[84:87], v2, s[8:11], s28 offen offset:0 nt
    s_waitcnt lgkmcnt(4)
    buffer_store_dwordx4 v[88:91], v2, s[8:11], s28 offen offset:1024 nt
    s_waitcnt lgkmcnt(3)
    buffer_store_dwordx4 v[92:95], v2, s[8:11], s28 offen offset:2048 nt
    s_waitcnt lgkmcnt(2)
    buffer_store_dwordx4 v[96:99], v2, s[8:11], s28 offen offset:3072 nt
    s_waitcnt lgkmcnt(1)
    buffer_store_dwordx4 v[100:103], v4, s[8:11], s28 offen offset:0 nt
    s_waitcnt lgkmcnt(0)
    buffer_store_dwordx4 v[104:107], v4, s[8:11], s28 offen offset:1024 nt
    s_endpgm
L_loopA_pre:
    s_branch L_loopA
L_roleB:
    s_setprio 2
    ds_read_b128 v[232:235], v5 offset:2304
    ds_read_b128 v[236:239], v5 offset:2336
    ds_read_b128 v[240:243], v5 offset:2368
    ds_read_b128 v[244:247], v5 offset:2400
    ds_read_b128 v[248:251], v5 offset:2432
    ds_read_b128 v[252:255], v5 offset:2464
    s_add_u32 m0, s23, 12288
    s_nop 0
    buffer_load_dwordx4 v20, s[12:15], s70 offen lds
    s_add_u32 m0, s23, 16384
    s_nop 0
    buffer_load_dwordx4 v20, s[12:15], s71 offen lds
    s_add_u32 m0, s23, 20480
    s_nop 0
    buffer_load_dwordx4 v20, s[12:15], s72 offen lds
    v_add_u32 v20, s22, v20
    s_add_u32 m0, s23, 24576
    s_nop 0
    buffer_load_dwordx4 v20, s[12:15], s70 offen lds
    s_add_u32 m0, s23, 28672
    s_nop 0
    buffer_load_dwordx4 v20, s[12:15], s71 offen lds
    s_add_u32 m0, s23, 32768
    s_nop 0
    buffer_load_dwordx4 v20, s[12:15], s72 offen lds
    v_add_u32 v20, s22, v20
    s_mov_b32 s29, s27
    s_add_u32 s27, s27, 12582912
    s_cmp_eq_u32 s26, 1
    s_cselect_b32 s6, 0, 50331648
    s_waitcnt lgkmcnt(5)
    v_dot2_f32_bf16 v228, v84, v232, 0
    v_dot2_f32_bf16 v229, v85, v233, 0
    v_dot2_f32_bf16 v230, v86, v234, 0
    v_dot2_f32_bf16 v231, v87, v235, 0
    ds_read_b128 v[232:235], v6 offset:0
    s_waitcnt lgkmcnt(5)
    v_dot2_f32_bf16 v228, v88, v236, v228
    v_dot2_f32_bf16 v229, v89, v237, v229
    v_dot2_f32_bf16 v230, v90, v238, v230
    v_dot2_f32_bf16 v231, v91, v239, v231
    ds_read_b128 v[236:239], v6 offset:1024
    s_waitcnt lgkmcnt(5)
    v_dot2_f32_bf16 v228, v92, v240, v228
    v_dot2_f32_bf16 v229, v93, v241, v229
    v_dot2_f32_bf16 v230, v94, v242, v230
    v_dot2_f32_bf16 v231, v95, v243, v231
    ds_read_b128 v[240:243], v6 offset:2048
    s_waitcnt lgkmcnt(5)
    v_dot2_f32_bf16 v228, v96, v244, v228
    v_dot2_f32_bf16 v229, v97, v245, v229
    v_dot2_f32_bf16 v230, v98, v246, v230
    v_dot2_f32_bf16 v231, v99, v247, v231
    ds_read_b128 v[244:247], v6 offset:3072
    s_waitcnt lgkmcnt(5)
    v_dot2_f32_bf16 v228, v100, v248, v228
    v_dot2_f32_bf16 v229, v101, v249, v229
    v_dot2_f32_bf16 v230, v102, v250, v230
    v_dot2_f32_bf16 v231, v103, v251, v231
    ds_read_b128 v[248:251], v6 offset:4096
    s_waitcnt lgkmcnt(5)
    v_dot2_f32_bf16 v228, v104, v252, v228
    v_dot2_f32_bf16 v229, v105, v253, v229
    v_dot2_f32_bf16 v230, v106, v254, v230
    v_dot2_f32_bf16 v231, v107, v255, v231
    ds_read_b128 v[252:255], v6 offset:5120
    v_add_f32 v228, v228, v229
    v_add_f32 v230, v230, v231
    v_add_f32 v228, v228, v230
    v_mov_b32 v9, v228
    s_nop 1
    v_permlane32_swap_b32 v9, v228
    v_add_f32 v228, v228, v9
    v_mul_f32 v204, s31, v228
    v_mul_f32 v205, s31, v228
    v_mul_f32 v206, s31, v228
    v_mul_f32 v207, s31, v228
    v_mul_f32 v208, s31, v228
    v_mul_f32 v209, s31, v228
    v_mul_f32 v210, s31, v228
    v_mul_f32 v211, s31, v228
    v_mul_f32 v212, s31, v228
    v_mul_f32 v213, s31, v228
    v_mul_f32 v214, s31, v228
    v_mul_f32 v215, s31, v228
    v_mul_f32 v216, s31, v228
    v_mul_f32 v217, s31, v228
    v_mul_f32 v218, s31, v228
    v_mul_f32 v219, s31, v228
    s_waitcnt lgkmcnt(5)
    s_nop 0
    v_mfma_f32_32x32x16_bf16 v[156:171], v[232:235], v[84:87], v[204:219]
    s_waitcnt lgkmcnt(3)
    v_mfma_f32_32x32x16_bf16 v[172:187], v[240:243], v[92:95], v[204:219]
    s_waitcnt lgkmcnt(1)
    v_mfma_f32_32x32x16_bf16 v[188:203], v[248:251], v[100:103], v[204:219]
    v_mfma_f32_32x32x16_bf16 v[156:171], v[236:239], v[88:91], v[156:171]
    v_mfma_f32_32x32x16_bf16 v[172:187], v[244:247], v[96:99], v[172:187]
    s_waitcnt lgkmcnt(0)
    v_mfma_f32_32x32x16_bf16 v[188:203], v[252:255], v[104:107], v[188:203]
    s_waitcnt vmcnt(6)
    s_barrier
    ds_read_b64_tr_b16 v[232:233], v1 offset:0
    ds_read_b64_tr_b16 v[234:235], v1 offset:256
    ds_read_b64_tr_b16 v[236:237], v1 offset:1024
    ds_read_b64_tr_b16 v[238:239], v1 offset:1280
    ds_read_b64_tr_b16 v[240:241], v1 offset:2048
    ds_read_b64_tr_b16 v[242:243], v1 offset:2304
    s_nop 0
    v_mul_f32 v228, v156, v156
    v_mul_f32 v229, v157, v157
    v_mul_f32 v230, v158, v158
    v_mul_f32_e64 v231, v159, v159
    v_fma_f32 v228, v160, v160, v228
    v_fma_f32 v229, v161, v161, v229
    v_fma_f32 v230, v162, v162, v230
    v_fma_f32 v231, v163, v163, v231
    v_fma_f32 v228, v164, v164, v228
    v_fma_f32 v229, v165, v165, v229
    v_fma_f32 v230, v166, v166, v230
    v_fma_f32 v231, v167, v167, v231
    v_fma_f32 v228, v168, v168, v228
    v_fma_f32 v229, v169, v169, v229
    v_fma_f32 v230, v170, v170, v230
    v_fma_f32 v231, v171, v171, v231
    v_fma_f32 v228, v172, v172, v228
    v_fma_f32 v229, v173, v173, v229
    v_fma_f32 v230, v174, v174, v230
    v_fma_f32 v231, v175, v175, v231
    v_fma_f32 v228, v176, v176, v228
    v_fma_f32 v229, v177, v177, v229
    v_fma_f32 v230, v178, v178, v230
    v_fma_f32 v231, v179, v179, v231
    v_fma_f32 v228, v180, v180, v228
    v_fma_f32 v229, v181, v181, v229
    v_fma_f32 v230, v182, v182, v230
    v_fma_f32 v231, v183, v183, v231
    v_fma_f32 v228, v184, v184, v228
    v_fma_f32 v229, v185, v185, v229
    v_fma_f32 v230, v186, v186, v230
    v_fma_f32 v231, v187, v187, v231
    v_fma_f32 v228, v188, v188, v228
    v_fma_f32 v229, v189, v189, v229
    v_fma_f32 v230, v190, v190, v230
    v_fma_f32 v231, v191, v191, v231
    v_fma_f32 v228, v192, v192, v228
    v_fma_f32 v229, v193, v193, v229
    v_fma_f32 v230, v194, v194, v230
    v_fma_f32 v231, v195, v195, v231
    v_fma_f32 v228, v196, v196, v228
    v_fma_f32 v229, v197, v197, v229
    v_fma_f32 v230, v198, v198, v230
    v_fma_f32 v231, v199, v199, v231
    v_fma_f32 v228, v200, v200, v228
    v_fma_f32 v229, v201, v201, v229
    v_fma_f32 v230, v202, v202, v230
    v_fma_f32 v231, v203, v203, v231
    v_add_f32 v228, v228, v229
    v_add_f32 v230, v230, v231
    v_add_f32 v228, v228, v230
    v_mov_b32 v9, v228
    s_nop 1
    v_permlane32_swap_b32 v9, v228
    v_add_f32_e64 v228, v228, v9
    v_fma_f32 v228, v228, s32, v11
    v_rsq_f32 v8, v228
    s_nop 0
    v_mul_f32 v156, v8, v156
    v_mul_f32 v157, v8, v157
    v_mul_f32 v158, v8, v158
    v_mul_f32 v159, v8, v159
    v_mul_f32 v160, v8, v160
    v_mul_f32 v161, v8, v161
    v_mul_f32 v162, v8, v162
    v_mul_f32 v163, v8, v163
    v_mul_f32 v164, v8, v164
    v_mul_f32 v165, v8, v165
    v_mul_f32 v166, v8, v166
    v_mul_f32 v167, v8, v167
    v_mul_f32 v168, v8, v168
    v_mul_f32 v169, v8, v169
    v_mul_f32 v170, v8, v170
    v_mul_f32 v171, v8, v171
    v_cvt_pk_bf16_f32 v36, v156, v157
    v_cvt_pk_bf16_f32 v37, v158, v159
    v_cvt_pk_bf16_f32 v38, v160, v161
    v_cvt_pk_bf16_f32 v39, v162, v163
    v_cvt_pk_bf16_f32 v40, v164, v165
    v_cvt_pk_bf16_f32 v41, v166, v167
    v_cvt_pk_bf16_f32 v42, v168, v169
    v_cvt_pk_bf16_f32 v43, v170, v171
    ds_read_b128 v[156:159], v5 offset:0
    ds_read_b128 v[160:163], v5 offset:32
    ds_read_b128 v[164:167], v5 offset:64
    ds_read_b128 v[168:171], v5 offset:96
    v_mul_f32 v172, v8, v172
    v_mul_f32 v173, v8, v173
    v_mul_f32 v174, v8, v174
    v_mul_f32 v175, v8, v175
    v_mul_f32 v176, v8, v176
    v_mul_f32 v177, v8, v177
    v_mul_f32 v178, v8, v178
    v_mul_f32 v179, v8, v179
    v_mul_f32 v180, v8, v180
    v_mul_f32 v181, v8, v181
    v_mul_f32 v182, v8, v182
    v_mul_f32 v183, v8, v183
    v_mul_f32 v184, v8, v184
    v_mul_f32 v185, v8, v185
    v_mul_f32 v186, v8, v186
    v_mul_f32 v187, v8, v187
    v_cvt_pk_bf16_f32 v44, v172, v173
    v_cvt_pk_bf16_f32 v45, v174, v175
    v_cvt_pk_bf16_f32 v46, v176, v177
    v_cvt_pk_bf16_f32 v47, v178, v179
    v_cvt_pk_bf16_f32 v48, v180, v181
    v_cvt_pk_bf16_f32 v49, v182, v183
    v_cvt_pk_bf16_f32 v50, v184, v185
    v_cvt_pk_bf16_f32 v51, v186, v187
    v_mul_f32 v188, v8, v188
    v_mul_f32 v189, v8, v189
    v_mul_f32 v190, v8, v190
    v_mul_f32 v191, v8, v191
    v_mul_f32 v192, v8, v192
    v_mul_f32 v193, v8, v193
    v_mul_f32 v194, v8, v194
    v_mul_f32 v195, v8, v195
    v_mul_f32 v196, v8, v196
    v_mul_f32 v197, v8, v197
    v_mul_f32 v198, v8, v198
    v_mul_f32 v199, v8, v199
    v_mul_f32 v200, v8, v200
    v_mul_f32 v201, v8, v201
    v_mul_f32 v202, v8, v202
    v_mul_f32 v203, v8, v203
    v_cvt_pk_bf16_f32 v52, v188, v189
    v_cvt_pk_bf16_f32 v53, v190, v191
    v_cvt_pk_bf16_f32 v54, v192, v193
    v_cvt_pk_bf16_f32 v55, v194, v195
    v_cvt_pk_bf16_f32 v56, v196, v197
    v_cvt_pk_bf16_f32 v57, v198, v199
    v_cvt_pk_bf16_f32 v58, v200, v201
    v_cvt_pk_bf16_f32 v59, v202, v203
    s_waitcnt lgkmcnt(0)
    v_mfma_f32_32x32x16_bf16 v[156:171], v[232:235], v[36:39], v[156:171]
    ds_read_b64_tr_b16 v[232:233], v1 offset:3072
    ds_read_b64_tr_b16 v[234:235], v1 offset:3328
    v_mfma_f32_32x32x16_bf16 v[156:171], v[236:239], v[40:43], v[156:171]
    ds_read_b64_tr_b16 v[236:237], v1 offset:4096
    ds_read_b64_tr_b16 v[238:239], v1 offset:4352
    v_mfma_f32_32x32x16_bf16 v[156:171], v[240:243], v[44:47], v[156:171]
    ds_read_b64_tr_b16 v[240:241], v1 offset:5120
    ds_read_b64_tr_b16 v[242:243], v1 offset:5376
    s_waitcnt lgkmcnt(4)
    v_mfma_f32_32x32x16_bf16 v[156:171], v[232:235], v[48:51], v[156:171]
    ds_read_b64_tr_b16 v[232:233], v1 offset:6144
    ds_read_b64_tr_b16 v[234:235], v1 offset:6400
    s_waitcnt lgkmcnt(4)
    v_mfma_f32_32x32x16_bf16 v[156:171], v[236:239], v[52:55], v[156:171]
    ds_read_b64_tr_b16 v[236:237], v1 offset:7168
    ds_read_b64_tr_b16 v[238:239], v1 offset:7424
    s_waitcnt lgkmcnt(4)
    v_mfma_f32_32x32x16_bf16 v[156:171], v[240:243], v[56:59], v[156:171]
    ds_read_b64_tr_b16 v[240:241], v1 offset:8192
    ds_read_b64_tr_b16 v[242:243], v1 offset:8448
    ds_read_b128 v[172:175], v5 offset:128
    ds_read_b128 v[176:179], v5 offset:160
    ds_read_b128 v[180:183], v5 offset:192
    ds_read_b128 v[184:187], v5 offset:224
    s_nop 7
    s_branch L_stepsB
.p2align 6
L_loopB:
    s_waitcnt vmcnt(0) lgkmcnt(0)
    s_setprio 1
    ds_read_b128 v[156:159], v5 offset:1920
    ds_read_b128 v[160:163], v5 offset:1952
    ds_read_b128 v[164:167], v5 offset:1984
    ds_read_b128 v[168:171], v5 offset:2016
    ds_read_b128 v[172:175], v5 offset:2048
    ds_read_b128 v[176:179], v5 offset:2080
    ds_read_b128 v[180:183], v5 offset:2112
    ds_read_b128 v[184:187], v5 offset:2144
    ds_read_b128 v[188:191], v5 offset:2176
    ds_read_b128 v[192:195], v5 offset:2208
    ds_read_b128 v[196:199], v5 offset:2240
    ds_read_b128 v[200:203], v5 offset:2272
    s_waitcnt lgkmcnt(8)
    v_mfma_f32_32x32x16_bf16 v[156:171], v[12:15], v[60:63], v[156:171]
    v_mfma_f32_32x32x16_bf16 v[156:171], v[16:19], v[64:67], v[156:171]
    ds_read_b128 v[36:39], v5 offset:1536
    ds_read_b128 v[40:43], v5 offset:1568
    ds_read_b128 v[44:47], v5 offset:1600
    ds_read_b128 v[48:51], v5 offset:1632
    s_waitcnt lgkmcnt(8)
    v_mfma_f32_32x32x16_bf16 v[172:187], v[12:15], v[68:71], v[172:187]
    v_mfma_f32_32x32x16_bf16 v[172:187], v[16:19], v[72:75], v[172:187]
    ds_read_b128 v[204:207], v5 offset:1664
    ds_read_b128 v[208:211], v5 offset:1696
    ds_read_b128 v[212:215], v5 offset:1728
    ds_read_b128 v[216:219], v5 offset:1760
    s_waitcnt lgkmcnt(8)
    v_mfma_f32_32x32x16_bf16 v[188:203], v[12:15], v[76:79], v[188:203]
    v_mfma_f32_32x32x16_bf16 v[188:203], v[16:19], v[80:83], v[188:203]
    ds_read_b128 v[20:23], v5 offset:1792
    ds_read_b128 v[24:27], v5 offset:1824
    ds_read_b128 v[28:31], v5 offset:1856
    ds_read_b128 v[32:35], v5 offset:1888
    s_waitcnt lgkmcnt(11)
    v_fma_f32 v108, v108, v36, v156
    v_fma_f32 v109, v109, v37, v157
    v_fma_f32 v110, v110, v38, v158
    v_fma_f32 v111, v111, v39, v159
    s_waitcnt lgkmcnt(10)
    v_fma_f32 v112, v112, v40, v160
    v_fma_f32 v113, v113, v41, v161
    v_fma_f32 v114, v114, v42, v162
    v_fma_f32 v115, v115, v43, v163
    s_waitcnt lgkmcnt(9)
    v_fma_f32 v116, v116, v44, v164
    v_fma_f32 v117, v117, v45, v165
    v_fma_f32 v118, v118, v46, v166
    v_fma_f32 v119, v119, v47, v167
    s_waitcnt lgkmcnt(8)
    v_fma_f32 v120, v120, v48, v168
    v_fma_f32 v121, v121, v49, v169
    v_fma_f32 v122, v122, v50, v170
    v_fma_f32 v123, v123, v51, v171
    ds_read_b128 v[232:235], v5 offset:2304
    ds_read_b128 v[236:239], v5 offset:2336
    ds_read_b128 v[240:243], v5 offset:2368
    ds_read_b128 v[244:247], v5 offset:2400
    ds_read_b128 v[248:251], v5 offset:2432
    ds_read_b128 v[252:255], v5 offset:2464
    v_cvt_pk_bf16_f32 v108, v108, v109
    v_cvt_pk_bf16_f32 v109, v110, v111
    v_cvt_pk_bf16_f32 v110, v112, v113
    v_cvt_pk_bf16_f32 v111, v114, v115
    v_cvt_pk_bf16_f32 v112, v116, v117
    v_cvt_pk_bf16_f32 v113, v118, v119
    v_cvt_pk_bf16_f32 v114, v120, v121
    v_cvt_pk_bf16_f32 v115, v122, v123
    s_mov_b64 vcc, s[54:55]
    v_cndmask_b32_dpp v60, v112, v108, vcc quad_perm:[1,0,3,2] row_mask:0xf bank_mask:0xf
    v_cndmask_b32_dpp v61, v113, v109, vcc quad_perm:[1,0,3,2] row_mask:0xf bank_mask:0xf
    v_cndmask_b32_dpp v62, v114, v110, vcc quad_perm:[1,0,3,2] row_mask:0xf bank_mask:0xf
    v_cndmask_b32_dpp v63, v115, v111, vcc quad_perm:[1,0,3,2] row_mask:0xf bank_mask:0xf
    s_not_b64 vcc, vcc
    v_cndmask_b32_dpp v64, v108, v112, vcc quad_perm:[1,0,3,2] row_mask:0xf bank_mask:0xf
    v_cndmask_b32_dpp v65, v109, v113, vcc quad_perm:[1,0,3,2] row_mask:0xf bank_mask:0xf
    v_cndmask_b32_dpp v66, v110, v114, vcc quad_perm:[1,0,3,2] row_mask:0xf bank_mask:0xf
    v_cndmask_b32_dpp v67, v111, v115, vcc quad_perm:[1,0,3,2] row_mask:0xf bank_mask:0xf
    s_waitcnt lgkmcnt(13)
    v_fma_f32 v124, v124, v204, v172
    v_fma_f32 v125, v125, v205, v173
    v_fma_f32 v126, v126, v206, v174
    v_fma_f32 v127, v127, v207, v175
    s_waitcnt lgkmcnt(12)
    v_fma_f32 v128, v128, v208, v176
    v_fma_f32 v129, v129, v209, v177
    v_fma_f32 v130, v130, v210, v178
    v_fma_f32 v131, v131, v211, v179
    s_waitcnt lgkmcnt(11)
    v_fma_f32 v132, v132, v212, v180
    v_fma_f32 v133, v133, v213, v181
    v_fma_f32 v134, v134, v214, v182
    v_fma_f32 v135, v135, v215, v183
    s_waitcnt lgkmcnt(10)
    v_fma_f32 v136, v136, v216, v184
    v_fma_f32 v137, v137, v217, v185
    v_fma_f32 v138, v138, v218, v186
    v_fma_f32 v139, v139, v219, v187
    v_cvt_pk_bf16_f32 v124, v124, v125
    v_cvt_pk_bf16_f32 v125, v126, v127
    v_cvt_pk_bf16_f32 v126, v128, v129
    v_cvt_pk_bf16_f32 v127, v130, v131
    v_cvt_pk_bf16_f32 v128, v132, v133
    v_cvt_pk_bf16_f32 v129, v134, v135
    v_cvt_pk_bf16_f32 v130, v136, v137
    v_cvt_pk_bf16_f32 v131, v138, v139
    s_mov_b64 vcc, s[54:55]
    v_cndmask_b32_dpp v68, v128, v124, vcc quad_perm:[1,0,3,2] row_mask:0xf bank_mask:0xf
    v_cndmask_b32_dpp v69, v129, v125, vcc quad_perm:[1,0,3,2] row_mask:0xf bank_mask:0xf
    v_cndmask_b32_dpp v70, v130, v126, vcc quad_perm:[1,0,3,2] row_mask:0xf bank_mask:0xf
    v_cndmask_b32_dpp v71, v131, v127, vcc quad_perm:[1,0,3,2] row_mask:0xf bank_mask:0xf
    s_not_b64 vcc, vcc
    v_cndmask_b32_dpp v72, v124, v128, vcc quad_perm:[1,0,3,2] row_mask:0xf bank_mask:0xf
    v_cndmask_b32_dpp v73, v125, v129, vcc quad_perm:[1,0,3,2] row_mask:0xf bank_mask:0xf
    v_cndmask_b32_dpp v74, v126, v130, vcc quad_perm:[1,0,3,2] row_mask:0xf bank_mask:0xf
    v_cndmask_b32_dpp v75, v127, v131, vcc quad_perm:[1,0,3,2] row_mask:0xf bank_mask:0xf
    s_waitcnt lgkmcnt(9)
    v_fma_f32 v140, v140, v20, v188
    v_fma_f32 v141, v141, v21, v189
    v_fma_f32 v142, v142, v22, v190
    v_fma_f32 v143, v143, v23, v191
    s_waitcnt lgkmcnt(8)
    v_fma_f32 v144, v144, v24, v192
    v_fma_f32 v145, v145, v25, v193
    v_fma_f32 v146, v146, v26, v194
    v_fma_f32 v147, v147, v27, v195
    s_waitcnt lgkmcnt(7)
    v_fma_f32 v148, v148, v28, v196
    v_fma_f32 v149, v149, v29, v197
    v_fma_f32 v150, v150, v30, v198
    v_fma_f32 v151, v151, v31, v199
    s_waitcnt lgkmcnt(6)
    v_fma_f32 v152, v152, v32, v200
    v_fma_f32 v153, v153, v33, v201
    v_fma_f32 v154, v154, v34, v202
    v_fma_f32 v155, v155, v35, v203
    v_cvt_pk_bf16_f32 v140, v140, v141
    v_cvt_pk_bf16_f32 v141, v142, v143
    v_cvt_pk_bf16_f32 v142, v144, v145
    v_cvt_pk_bf16_f32 v143, v146, v147
    v_cvt_pk_bf16_f32 v144, v148, v149
    v_cvt_pk_bf16_f32 v145, v150, v151
    v_cvt_pk_bf16_f32 v146, v152, v153
    v_cvt_pk_bf16_f32 v147, v154, v155
    s_mov_b64 vcc, s[54:55]
    v_cndmask_b32_dpp v76, v144, v140, vcc quad_perm:[1,0,3,2] row_mask:0xf bank_mask:0xf
    v_cndmask_b32_dpp v77, v145, v141, vcc quad_perm:[1,0,3,2] row_mask:0xf bank_mask:0xf
    v_cndmask_b32_dpp v78, v146, v142, vcc quad_perm:[1,0,3,2] row_mask:0xf bank_mask:0xf
    v_cndmask_b32_dpp v79, v147, v143, vcc quad_perm:[1,0,3,2] row_mask:0xf bank_mask:0xf
    s_not_b64 vcc, vcc
    v_cndmask_b32_dpp v80, v140, v144, vcc quad_perm:[1,0,3,2] row_mask:0xf bank_mask:0xf
    v_cndmask_b32_dpp v81, v141, v145, vcc quad_perm:[1,0,3,2] row_mask:0xf bank_mask:0xf
    v_cndmask_b32_dpp v82, v142, v146, vcc quad_perm:[1,0,3,2] row_mask:0xf bank_mask:0xf
    v_cndmask_b32_dpp v83, v143, v147, vcc quad_perm:[1,0,3,2] row_mask:0xf bank_mask:0xf
    s_mov_b32 s29, s27
    s_add_u32 s27, s27, 12582912
    s_cmp_eq_u32 s26, 1
    s_cselect_b32 s6, 0, 50331648
    s_waitcnt lgkmcnt(5)
    v_dot2_f32_bf16 v228, v84, v232, 0
    v_dot2_f32_bf16 v229, v85, v233, 0
    v_dot2_f32_bf16 v230, v86, v234, 0
    v_dot2_f32_bf16 v231, v87, v235, 0
    ds_read_b128 v[232:235], v6 offset:0
    s_waitcnt lgkmcnt(5)
    v_dot2_f32_bf16 v228, v88, v236, v228
    v_dot2_f32_bf16 v229, v89, v237, v229
    v_dot2_f32_bf16 v230, v90, v238, v230
    v_dot2_f32_bf16 v231, v91, v239, v231
    ds_read_b128 v[236:239], v6 offset:1024
    s_waitcnt lgkmcnt(5)
    v_dot2_f32_bf16 v228, v92, v240, v228
    v_dot2_f32_bf16 v229, v93, v241, v229
    v_dot2_f32_bf16 v230, v94, v242, v230
    v_dot2_f32_bf16 v231, v95, v243, v231
    ds_read_b128 v[240:243], v6 offset:2048
    s_waitcnt lgkmcnt(5)
    v_dot2_f32_bf16 v228, v96, v244, v228
    v_dot2_f32_bf16 v229, v97, v245, v229
    v_dot2_f32_bf16 v230, v98, v246, v230
    v_dot2_f32_bf16 v231, v99, v247, v231
    ds_read_b128 v[244:247], v6 offset:3072
    s_waitcnt lgkmcnt(5)
    v_dot2_f32_bf16 v228, v100, v248, v228
    v_dot2_f32_bf16 v229, v101, v249, v229
    v_dot2_f32_bf16 v230, v102, v250, v230
    v_dot2_f32_bf16 v231, v103, v251, v231
    ds_read_b128 v[248:251], v6 offset:4096
    s_waitcnt lgkmcnt(5)
    v_dot2_f32_bf16 v228, v104, v252, v228
    v_dot2_f32_bf16 v229, v105, v253, v229
    v_dot2_f32_bf16 v230, v106, v254, v230
    v_dot2_f32_bf16 v231, v107, v255, v231
    ds_read_b128 v[252:255], v6 offset:5120
    v_add_f32 v228, v228, v229
    v_add_f32 v230, v230, v231
    v_add_f32 v228, v228, v230
    v_mov_b32 v9, v228
    s_nop 1
    v_permlane32_swap_b32 v9, v228
    v_add_f32 v228, v228, v9
    v_mul_f32 v204, s31, v228
    v_mul_f32 v205, s31, v228
    v_mul_f32 v206, s31, v228
    v_mul_f32 v207, s31, v228
    v_mul_f32 v208, s31, v228
    v_mul_f32 v209, s31, v228
    v_mul_f32 v210, s31, v228
    v_mul_f32 v211, s31, v228
    v_mul_f32 v212, s31, v228
    v_mul_f32 v213, s31, v228
    v_mul_f32 v214, s31, v228
    v_mul_f32 v215, s31, v228
    v_mul_f32 v216, s31, v228
    v_mul_f32 v217, s31, v228
    v_mul_f32_e64 v218, s31, v228
    v_mul_f32 v219, s31, v228
    s_waitcnt lgkmcnt(5)
    s_nop 0
    v_mfma_f32_32x32x16_bf16 v[156:171], v[232:235], v[84:87], v[204:219]
    s_waitcnt lgkmcnt(3)
    v_mfma_f32_32x32x16_bf16 v[172:187], v[240:243], v[92:95], v[204:219]
    s_waitcnt lgkmcnt(1)
    v_mfma_f32_32x32x16_bf16 v[188:203], v[248:251], v[100:103], v[204:219]
    v_mfma_f32_32x32x16_bf16 v[156:171], v[236:239], v[88:91], v[156:171]
    v_mfma_f32_32x32x16_bf16 v[172:187], v[244:247], v[96:99], v[172:187]
    s_waitcnt lgkmcnt(0)
    v_mfma_f32_32x32x16_bf16 v[188:203], v[252:255], v[104:107], v[188:203]
    ds_read_b64_tr_b16 v[232:233], v1 offset:0
    ds_read_b64_tr_b16 v[234:235], v1 offset:256
    ds_read_b64_tr_b16 v[236:237], v1 offset:1024
    ds_read_b64_tr_b16 v[238:239], v1 offset:1280
    ds_read_b64_tr_b16 v[240:241], v1 offset:2048
    ds_read_b64_tr_b16 v[242:243], v1 offset:2304
    s_setprio 0
    s_nop 1
    v_mul_f32 v228, v156, v156
    v_mul_f32 v229, v157, v157
    v_mul_f32 v230, v158, v158
    v_mul_f32 v231, v159, v159
    v_fma_f32 v228, v160, v160, v228
    v_fma_f32 v229, v161, v161, v229
    v_fma_f32 v230, v162, v162, v230
    v_fma_f32 v231, v163, v163, v231
    v_fma_f32 v228, v164, v164, v228
    v_fma_f32 v229, v165, v165, v229
    v_fma_f32 v230, v166, v166, v230
    v_fma_f32 v231, v167, v167, v231
    v_fma_f32 v228, v168, v168, v228
    v_fma_f32 v229, v169, v169, v229
    v_fma_f32 v230, v170, v170, v230
    v_fma_f32 v231, v171, v171, v231
    v_fma_f32 v228, v172, v172, v228
    v_fma_f32 v229, v173, v173, v229
    v_fma_f32 v230, v174, v174, v230
    v_fma_f32 v231, v175, v175, v231
    v_fma_f32 v228, v176, v176, v228
    v_fma_f32 v229, v177, v177, v229
    v_fma_f32 v230, v178, v178, v230
    v_fma_f32 v231, v179, v179, v231
    v_fma_f32 v228, v180, v180, v228
    v_fma_f32 v229, v181, v181, v229
    v_fma_f32 v230, v182, v182, v230
    v_fma_f32 v231, v183, v183, v231
    v_fma_f32 v228, v184, v184, v228
    v_fma_f32 v229, v185, v185, v229
    v_fma_f32 v230, v186, v186, v230
    v_fma_f32 v231, v187, v187, v231
    v_fma_f32 v228, v188, v188, v228
    v_fma_f32 v229, v189, v189, v229
    v_fma_f32 v230, v190, v190, v230
    v_fma_f32 v231, v191, v191, v231
    v_fma_f32 v228, v192, v192, v228
    v_fma_f32 v229, v193, v193, v229
    v_fma_f32 v230, v194, v194, v230
    v_fma_f32 v231, v195, v195, v231
    v_fma_f32 v228, v196, v196, v228
    v_fma_f32 v229, v197, v197, v229
    v_fma_f32 v230, v198, v198, v230
    v_fma_f32 v231, v199, v199, v231
    v_fma_f32 v228, v200, v200, v228
    v_fma_f32 v229, v201, v201, v229
    v_fma_f32 v230, v202, v202, v230
    v_fma_f32 v231, v203, v203, v231
    v_add_f32 v228, v228, v229
    v_add_f32 v230, v230, v231
    v_add_f32 v228, v228, v230
    v_mov_b32 v9, v228
    s_nop 1
    v_permlane32_swap_b32 v9, v228
    v_add_f32_e64 v228, v228, v9
    v_fma_f32 v228, v228, s32, v11
    v_rsq_f32 v8, v228
    s_nop 0
    v_mul_f32 v156, v8, v156
    v_mul_f32 v157, v8, v157
    v_mul_f32 v158, v8, v158
    v_mul_f32 v159, v8, v159
    v_mul_f32 v160, v8, v160
    v_mul_f32 v161, v8, v161
    v_mul_f32 v162, v8, v162
    v_mul_f32 v163, v8, v163
    v_mul_f32 v164, v8, v164
    v_mul_f32 v165, v8, v165
    v_mul_f32 v166, v8, v166
    v_mul_f32 v167, v8, v167
    v_mul_f32 v168, v8, v168
    v_mul_f32 v169, v8, v169
    v_mul_f32 v170, v8, v170
    v_mul_f32 v171, v8, v171
    v_cvt_pk_bf16_f32 v36, v156, v157
    v_cvt_pk_bf16_f32 v37, v158, v159
    v_cvt_pk_bf16_f32 v38, v160, v161
    v_cvt_pk_bf16_f32 v39, v162, v163
    v_cvt_pk_bf16_f32 v40, v164, v165
    v_cvt_pk_bf16_f32 v41, v166, v167
    v_cvt_pk_bf16_f32 v42, v168, v169
    v_cvt_pk_bf16_f32 v43, v170, v171
    ds_read_b128 v[156:159], v5 offset:0
    ds_read_b128 v[160:163], v5 offset:32
    ds_read_b128 v[164:167], v5 offset:64
    ds_read_b128 v[168:171], v5 offset:96
    v_mul_f32 v172, v8, v172
    v_mul_f32 v173, v8, v173
    v_mul_f32 v174, v8, v174
    v_mul_f32 v175, v8, v175
    v_mul_f32 v176, v8, v176
    v_mul_f32 v177, v8, v177
    v_mul_f32 v178, v8, v178
    v_mul_f32 v179, v8, v179
    v_mul_f32 v180, v8, v180
    v_mul_f32 v181, v8, v181
    v_mul_f32 v182, v8, v182
    v_mul_f32 v183, v8, v183
    v_mul_f32 v184, v8, v184
    v_mul_f32 v185, v8, v185
    v_mul_f32 v186, v8, v186
    v_mul_f32 v187, v8, v187
    v_cvt_pk_bf16_f32 v44, v172, v173
    v_cvt_pk_bf16_f32 v45, v174, v175
    v_cvt_pk_bf16_f32 v46, v176, v177
    v_cvt_pk_bf16_f32 v47, v178, v179
    v_cvt_pk_bf16_f32 v48, v180, v181
    v_cvt_pk_bf16_f32 v49, v182, v183
    v_cvt_pk_bf16_f32 v50, v184, v185
    v_cvt_pk_bf16_f32 v51, v186, v187
    v_mul_f32 v188, v8, v188
    v_mul_f32 v189, v8, v189
    v_mul_f32 v190, v8, v190
    v_mul_f32 v191, v8, v191
    v_mul_f32 v192, v8, v192
    v_mul_f32 v193, v8, v193
    v_mul_f32 v194, v8, v194
    v_mul_f32 v195, v8, v195
    v_mul_f32 v196, v8, v196
    v_mul_f32 v197, v8, v197
    v_mul_f32 v198, v8, v198
    v_mul_f32 v199, v8, v199
    v_mul_f32 v200, v8, v200
    v_mul_f32 v201, v8, v201
    v_mul_f32 v202, v8, v202
    v_mul_f32 v203, v8, v203
    v_cvt_pk_bf16_f32 v52, v188, v189
    v_cvt_pk_bf16_f32 v53, v190, v191
    v_cvt_pk_bf16_f32 v54, v192, v193
    v_cvt_pk_bf16_f32 v55, v194, v195
    v_cvt_pk_bf16_f32 v56, v196, v197
    v_cvt_pk_bf16_f32 v57, v198, v199
    v_cvt_pk_bf16_f32 v58, v200, v201
    v_cvt_pk_bf16_f32 v59, v202, v203
    s_waitcnt lgkmcnt(0)
    v_mfma_f32_32x32x16_bf16 v[156:171], v[232:235], v[36:39], v[156:171]
    ds_read_b64_tr_b16 v[232:233], v1 offset:3072
    ds_read_b64_tr_b16 v[234:235], v1 offset:3328
    v_mfma_f32_32x32x16_bf16 v[156:171], v[236:239], v[40:43], v[156:171]
    ds_read_b64_tr_b16 v[236:237], v1 offset:4096
    ds_read_b64_tr_b16 v[238:239], v1 offset:4352
    v_mfma_f32_32x32x16_bf16 v[156:171], v[240:243], v[44:47], v[156:171]
    ds_read_b64_tr_b16 v[240:241], v1 offset:5120
    ds_read_b64_tr_b16 v[242:243], v1 offset:5376
    s_waitcnt lgkmcnt(4)
    v_mfma_f32_32x32x16_bf16 v[156:171], v[232:235], v[48:51], v[156:171]
    ds_read_b64_tr_b16 v[232:233], v1 offset:6144
    ds_read_b64_tr_b16 v[234:235], v1 offset:6400
    s_waitcnt lgkmcnt(4)
    v_mfma_f32_32x32x16_bf16 v[156:171], v[236:239], v[52:55], v[156:171]
    ds_read_b64_tr_b16 v[236:237], v1 offset:7168
    ds_read_b64_tr_b16 v[238:239], v1 offset:7424
    s_waitcnt lgkmcnt(4)
    v_mfma_f32_32x32x16_bf16 v[156:171], v[240:243], v[56:59], v[156:171]
    ds_read_b64_tr_b16 v[240:241], v1 offset:8192
    ds_read_b64_tr_b16 v[242:243], v1 offset:8448
    ds_read_b128 v[172:175], v5 offset:128
    ds_read_b128 v[176:179], v5 offset:160
    ds_read_b128 v[180:183], v5 offset:192
    ds_read_b128 v[184:187], v5 offset:224
L_stepsB:
    s_waitcnt lgkmcnt(0)
    s_nop 4
    v_fma_f32 v204, -v156, v156, s30
    v_fma_f32 v205, -v157, v157, s30
    v_fma_f32 v206, -v158, v158, s30
    v_fma_f32 v207, -v159, v159, s30
    v_fma_f32 v208, -v160, v160, s30
    v_fma_f32 v209, -v161, v161, s30
    v_fma_f32 v210, -v162, v162, s30
    v_fma_f32 v211, -v163, v163, s30
    v_mul_f32 v204, v204, v156
    v_mul_f32 v205, v205, v157
    v_mul_f32 v206, v206, v158
    v_mul_f32 v207, v207, v159
    v_mul_f32 v208, v208, v160
    v_mul_f32 v209, v209, v161
    v_mul_f32 v210, v210, v162
    v_mul_f32 v211, v211, v163
    ds_read_b64_tr_b16 v[232:233], v1 offset:6144
    ds_read_b64_tr_b16 v[234:235], v1 offset:6400
    ds_read_b64_tr_b16 v[236:237], v1 offset:7168
    ds_read_b64_tr_b16 v[238:239], v1 offset:7424
    ds_read_b64_tr_b16 v[240:241], v1 offset:8192
    ds_read_b64_tr_b16 v[242:243], v1 offset:8448
    ds_read_b128 v[188:191], v5 offset:256
    ds_read_b128 v[192:195], v5 offset:288
    s_setprio 1
    s_waitcnt lgkmcnt(2)
    v_mfma_f32_32x32x16_bf16 v[172:187], v[232:235], v[36:39], v[172:187]
    v_exp_f32 v204, v204
    v_exp_f32 v205, v205
    v_exp_f32_e64 v206, v206
    v_mfma_f32_32x32x16_bf16 v[172:187], v[236:239], v[40:43], v[172:187]
    v_exp_f32 v207, v207
    v_exp_f32 v208, v208
    v_exp_f32_e64 v209, v209
    v_mfma_f32_32x32x16_bf16 v[172:187], v[240:243], v[44:47], v[172:187]
    v_exp_f32 v210, v210
    v_exp_f32 v211, v211
    s_setprio 2
    s_cmp_lg_u32 s26, 4
    s_cbranch_scc1 L_nb0_1
    s_waitcnt vmcnt(0)
    s_barrier
    s_add_u32 m0, s23, 36864
    s_nop 0
    buffer_load_dwordx4 v20, s[12:15], s70 offen lds
    s_add_u32 m0, s23, 40960
    s_nop 0
    buffer_load_dwordx4 v20, s[12:15], s71 offen lds
    s_add_u32 m0, s23, 45056
    s_nop 0
    buffer_load_dwordx4 v20, s[12:15], s72 offen lds
    v_add_u32 v20, s22, v20
L_nb0_1:
    v_add_f32 v204, 1.0, v204
    v_add_f32 v205, 1.0, v205
    v_add_f32 v206, 1.0, v206
    v_add_f32 v207, 1.0, v207
    v_add_f32 v208, 1.0, v208
    v_add_f32 v209, 1.0, v209
    v_add_f32 v210, 1.0, v210
    v_add_f32_e64 v211, 1.0, v211
    v_fma_f32 v212, -v164, v164, s30
    v_fma_f32 v213, -v165, v165, s30
    v_fma_f32 v214, -v166, v166, s30
    v_fma_f32 v215, -v167, v167, s30
    v_fma_f32 v216, -v168, v168, s30
    v_fma_f32 v217, -v169, v169, s30
    v_fma_f32 v218, -v170, v170, s30
    v_fma_f32 v219, -v171, v171, s30
    v_mul_f32 v212, v212, v164
    v_mul_f32 v213, v213, v165
    v_mul_f32 v214, v214, v166
    v_mul_f32 v215, v215, v167
    v_mul_f32 v216, v216, v168
    v_mul_f32 v217, v217, v169
    v_mul_f32 v218, v218, v170
    v_mul_f32 v219, v219, v171
    ds_read_b64_tr_b16 v[232:233], v1 offset:9216
    ds_read_b64_tr_b16 v[234:235], v1 offset:9472
    ds_read_b64_tr_b16 v[236:237], v1 offset:10240
    ds_read_b64_tr_b16 v[238:239], v1 offset:10496
    ds_read_b64_tr_b16 v[240:241], v1 offset:11264
    ds_read_b64_tr_b16 v[242:243], v1 offset:11520
    ds_read_b128 v[196:199], v5 offset:320
    ds_read_b128 v[200:203], v5 offset:352
    buffer_store_dwordx4 v[60:63], v10, s[8:11], s28 offen offset:0 nt
    s_setprio 1
    s_waitcnt lgkmcnt(2)
    v_mfma_f32_32x32x16_bf16 v[172:187], v[232:235], v[48:51], v[172:187]
    v_rcp_f32 v204, v204
    v_rcp_f32 v205, v205
    v_rcp_f32 v206, v206
    v_rcp_f32 v207, v207
    v_rcp_f32 v208, v208
    v_rcp_f32 v209, v209
    v_mfma_f32_32x32x16_bf16 v[172:187], v[236:239], v[52:55], v[172:187]
    v_rcp_f32 v210, v210
    v_rcp_f32 v211, v211
    v_exp_f32 v212, v212
    v_exp_f32 v213, v213
    v_exp_f32_e64 v214, v214
    v_mfma_f32_32x32x16_bf16 v[172:187], v[240:243], v[56:59], v[172:187]
    v_exp_f32 v215, v215
    v_exp_f32 v216, v216
    v_exp_f32 v217, v217
    v_exp_f32 v218, v218
    v_exp_f32 v219, v219
    s_setprio 2
    s_cmp_lg_u32 s26, 4
    s_cbranch_scc1 L_ng1_1
    s_add_u32 m0, s23, 49152
    s_nop 0
    buffer_load_dwordx4 v20, s[12:15], s70 offen lds
    s_add_u32 m0, s23, 53248
    s_nop 0
    buffer_load_dwordx4 v20, s[12:15], s71 offen lds
    s_add_u32 m0, s23, 57344
    s_nop 0
    buffer_load_dwordx4 v20, s[12:15], s72 offen lds
    v_add_u32 v20, s22, v20
L_ng1_1:
    v_mul_f32 v204, v204, v156
    v_mul_f32 v205, v205, v157
    v_mul_f32 v206, v206, v158
    v_mul_f32 v207, v207, v159
    v_mul_f32 v208, v208, v160
    v_mul_f32 v209, v209, v161
    v_mul_f32 v210, v210, v162
    v_mul_f32 v211, v211, v163
    v_add_f32 v212, 1.0, v212
    v_add_f32 v213, 1.0, v213
    v_add_f32 v214, 1.0, v214
    v_add_f32 v215, 1.0, v215
    v_add_f32 v216, 1.0, v216
    v_add_f32 v217, 1.0, v217
    v_add_f32 v218, 1.0, v218
    v_add_f32 v219, 1.0, v219
    v_fma_f32 v220, -v172, v172, s30
    v_fma_f32 v221, -v173, v173, s30
    v_fma_f32 v222, -v174, v174, s30
    v_fma_f32 v223, -v175, v175, s30
    v_fma_f32 v224, -v176, v176, s30
    v_fma_f32 v225, -v177, v177, s30
    v_fma_f32 v226, -v178, v178, s30
    v_fma_f32 v227, -v179, v179, s30
    v_mul_f32 v220, v220, v172
    v_mul_f32 v221, v221, v173
    v_mul_f32 v222, v222, v174
    v_mul_f32 v223, v223, v175
    v_mul_f32 v224, v224, v176
    v_mul_f32 v225, v225, v177
    v_mul_f32 v226, v226, v178
    v_mul_f32 v227, v227, v179
    ds_read_b64_tr_b16 v[232:233], v1 offset:12288
    ds_read_b64_tr_b16 v[234:235], v1 offset:12544
    ds_read_b64_tr_b16 v[236:237], v1 offset:13312
    ds_read_b64_tr_b16 v[238:239], v1 offset:13568
    ds_read_b64_tr_b16 v[240:241], v1 offset:14336
    ds_read_b64_tr_b16 v[242:243], v1 offset:14592
    ds_read_b64_tr_b16 v[244:245], v3 offset:0
    ds_read_b64_tr_b16 v[246:247], v3 offset:512
    ds_read_b64_tr_b16 v[248:249], v3 offset:1024
    ds_read_b64_tr_b16 v[250:251], v3 offset:1536
    ds_read_b64_tr_b16 v[252:253], v3 offset:2048
    ds_read_b64_tr_b16 v[254:255], v3 offset:2560
    ds_read_b128 v[156:159], v5 offset:384
    s_waitcnt lgkmcnt(14)
    ds_read_b128 v[160:163], v5 offset:416
    buffer_store_dwordx4 v[64:67], v10, s[8:11], s28 offen offset:192 nt
    s_setprio 1
    s_waitcnt lgkmcnt(8)
    v_mfma_f32_32x32x16_bf16 v[188:203], v[232:235], v[36:39], v[188:203]
    v_cvt_pk_bf16_f32 v228, v204, v205
    v_cvt_pk_bf16_f32 v229, v206, v207
    v_cvt_pk_bf16_f32 v230, v208, v209
    v_cvt_pk_bf16_f32 v231, v210, v211
    v_rcp_f32 v212, v212
    v_mfma_f32_32x32x16_bf16 v[188:203], v[236:239], v[40:43], v[188:203]
    v_rcp_f32 v213, v213
    v_rcp_f32 v214, v214
    v_rcp_f32_e64 v215, v215
    v_mfma_f32_32x32x16_bf16 v[188:203], v[240:243], v[44:47], v[188:203]
    v_rcp_f32 v216, v216
    v_rcp_f32 v217, v217
    v_rcp_f32 v218, v218
    s_waitcnt lgkmcnt(0)
    v_mfma_f32_32x32x16_bf16 v[108:123], v[244:247], v[228:231], 0
    v_rcp_f32 v219, v219
    v_exp_f32 v220, v220
    v_exp_f32_e64 v221, v221
    v_mfma_f32_32x32x16_bf16 v[124:139], v[248:251], v[228:231], 0
    v_exp_f32 v222, v222
    v_exp_f32 v223, v223
    v_exp_f32_e64 v224, v224
    v_mfma_f32_32x32x16_bf16 v[140:155], v[252:255], v[228:231], 0
    v_exp_f32 v225, v225
    v_exp_f32 v226, v226
    v_exp_f32 v227, v227
    s_setprio 2
    s_cmp_lg_u32 s26, 4
    s_cbranch_scc1 L_ng2_1
    s_add_u32 m0, s23, 61440
    s_nop 0
    buffer_load_dwordx4 v20, s[12:15], s70 offen lds
    s_add_u32 m0, s23, 65536
    s_nop 0
    buffer_load_dwordx4 v20, s[12:15], s71 offen lds
    s_add_u32 m0, s23, 69632
    s_nop 0
    buffer_load_dwordx4 v20, s[12:15], s72 offen lds
L_ng2_1:
    v_mul_f32 v212, v212, v164
    v_mul_f32 v213, v213, v165
    v_mul_f32 v214, v214, v166
    v_mul_f32 v215, v215, v167
    v_mul_f32 v216, v216, v168
    v_mul_f32 v217, v217, v169
    v_mul_f32 v218, v218, v170
    v_mul_f32 v219, v219, v171
    v_add_f32 v220, 1.0, v220
    v_add_f32 v221, 1.0, v221
    v_add_f32 v222, 1.0, v222
    v_add_f32 v223, 1.0, v223
    v_add_f32 v224, 1.0, v224
    v_add_f32 v225, 1.0, v225
    v_add_f32 v226, 1.0, v226
    v_add_f32_e64 v227, 1.0, v227
    v_fma_f32 v204, -v180, v180, s30
    v_fma_f32 v205, -v181, v181, s30
    v_fma_f32 v206, -v182, v182, s30
    v_fma_f32 v207, -v183, v183, s30
    v_fma_f32 v208, -v184, v184, s30
    v_fma_f32 v209, -v185, v185, s30
    v_fma_f32 v210, -v186, v186, s30
    v_fma_f32 v211, -v187, v187, s30
    v_mul_f32 v204, v204, v180
    v_mul_f32 v205, v205, v181
    v_mul_f32 v206, v206, v182
    v_mul_f32 v207, v207, v183
    v_mul_f32 v208, v208, v184
    v_mul_f32 v209, v209, v185
    v_mul_f32 v210, v210, v186
    v_mul_f32 v211, v211, v187
    ds_read_b64_tr_b16 v[232:233], v1 offset:15360
    ds_read_b64_tr_b16 v[234:235], v1 offset:15616
    ds_read_b64_tr_b16 v[236:237], v1 offset:16384
    ds_read_b64_tr_b16 v[238:239], v1 offset:16640
    ds_read_b64_tr_b16 v[240:241], v1 offset:17408
    ds_read_b64_tr_b16 v[242:243], v1 offset:17664
    ds_read_b64_tr_b16 v[244:245], v3 offset:3072
    ds_read_b64_tr_b16 v[246:247], v3 offset:3584
    ds_read_b64_tr_b16 v[248:249], v3 offset:4096
    ds_read_b64_tr_b16 v[250:251], v3 offset:4608
    ds_read_b64_tr_b16 v[252:253], v3 offset:5120
    ds_read_b64_tr_b16 v[254:255], v3 offset:5632
    ds_read_b128 v[164:167], v5 offset:448
    ds_read_b128 v[168:171], v5 offset:480
    buffer_store_dwordx4 v[68:71], v10, s[8:11], s28 offen offset:64 nt
    s_setprio 1
    s_waitcnt lgkmcnt(8)
    v_mfma_f32_32x32x16_bf16 v[188:203], v[232:235], v[48:51], v[188:203]
    v_cvt_pk_bf16_f32 v228, v212, v213
    v_cvt_pk_bf16_f32 v229, v214, v215
    v_cvt_pk_bf16_f32 v230, v216, v217
    v_cvt_pk_bf16_f32 v231, v218, v219
    v_rcp_f32_e64 v220, v220
    v_mfma_f32_32x32x16_bf16 v[188:203], v[236:239], v[52:55], v[188:203]
    v_rcp_f32 v221, v221
    v_rcp_f32 v222, v222
    v_rcp_f32_e64 v223, v223
    v_mfma_f32_32x32x16_bf16 v[188:203], v[240:243], v[56:59], v[188:203]
    v_rcp_f32 v224, v224
    v_rcp_f32 v225, v225
    v_rcp_f32 v226, v226
    s_waitcnt lgkmcnt(0)
    v_mfma_f32_32x32x16_bf16 v[108:123], v[244:247], v[228:231], v[108:123]
    v_rcp_f32 v227, v227
    v_exp_f32 v204, v204
    v_exp_f32_e64 v205, v205
    v_mfma_f32_32x32x16_bf16 v[124:139], v[248:251], v[228:231], v[124:139]
    v_exp_f32 v206, v206
    v_exp_f32 v207, v207
    v_exp_f32_e64 v208, v208
    v_mfma_f32_32x32x16_bf16 v[140:155], v[252:255], v[228:231], v[140:155]
    v_exp_f32 v209, v209
    v_exp_f32 v210, v210
    v_exp_f32 v211, v211
    s_setprio 2
    v_mul_f32 v220, v220, v172
    v_mul_f32 v221, v221, v173
    v_mul_f32 v222, v222, v174
    v_mul_f32 v223, v223, v175
    v_mul_f32 v224, v224, v176
    v_mul_f32 v225, v225, v177
    v_mul_f32 v226, v226, v178
    v_mul_f32 v227, v227, v179
    v_add_f32 v204, 1.0, v204
    v_add_f32 v205, 1.0, v205
    v_add_f32 v206, 1.0, v206
    v_add_f32 v207, 1.0, v207
    v_add_f32 v208, 1.0, v208
    v_add_f32 v209, 1.0, v209
    v_add_f32 v210, 1.0, v210
    v_add_f32 v211, 1.0, v211
    v_fma_f32 v212, -v188, v188, s30
    v_fma_f32 v213, -v189, v189, s30
    v_fma_f32 v214, -v190, v190, s30
    v_fma_f32 v215, -v191, v191, s30
    v_fma_f32 v216, -v192, v192, s30
    v_fma_f32 v217, -v193, v193, s30
    v_fma_f32 v218, -v194, v194, s30
    v_fma_f32 v219, -v195, v195, s30
    v_mul_f32 v212, v212, v188
    v_mul_f32 v213, v213, v189
    v_mul_f32 v214, v214, v190
    v_mul_f32 v215, v215, v191
    v_mul_f32 v216, v216, v192
    v_mul_f32 v217, v217, v193
    v_mul_f32 v218, v218, v194
    v_mul_f32 v219, v219, v195
    ds_read_b64_tr_b16 v[232:233], v1 offset:18432
    ds_read_b64_tr_b16 v[234:235], v1 offset:18688
    ds_read_b64_tr_b16 v[236:237], v1 offset:19456
    ds_read_b64_tr_b16 v[238:239], v1 offset:19712
    ds_read_b64_tr_b16 v[240:241], v1 offset:20480
    ds_read_b64_tr_b16 v[242:243], v1 offset:20736
    ds_read_b64_tr_b16 v[244:245], v3 offset:6144
    ds_read_b64_tr_b16 v[246:247], v3 offset:6656
    ds_read_b64_tr_b16 v[248:249], v3 offset:7168
    ds_read_b64_tr_b16 v[250:251], v3 offset:7680
    ds_read_b64_tr_b16 v[252:253], v3 offset:8192
    ds_read_b64_tr_b16 v[254:255], v3 offset:8704
    ds_read_b128 v[172:175], v5 offset:512
    ds_read_b128 v[176:179], v5 offset:544
    buffer_store_dwordx4 v[72:75], v10, s[8:11], s28 offen offset:256 nt
    s_setprio 1
    s_waitcnt lgkmcnt(8)
    v_mfma_f32_32x32x16_bf16 v[156:171], v[232:235], v[36:39], v[156:171]
    v_cvt_pk_bf16_f32 v228, v220, v221
    v_cvt_pk_bf16_f32 v229, v222, v223
    v_cvt_pk_bf16_f32 v230, v224, v225
    v_cvt_pk_bf16_f32 v231, v226, v227
    v_rcp_f32_e64 v204, v204
    v_mfma_f32_32x32x16_bf16 v[156:171], v[236:239], v[40:43], v[156:171]
    v_rcp_f32 v205, v205
    v_rcp_f32 v206, v206
    v_rcp_f32_e64 v207, v207
    v_mfma_f32_32x32x16_bf16 v[156:171], v[240:243], v[44:47], v[156:171]
    v_rcp_f32 v208, v208
    v_rcp_f32 v209, v209
    v_rcp_f32 v210, v210
    s_waitcnt lgkmcnt(0)
    v_mfma_f32_32x32x16_bf16 v[108:123], v[244:247], v[228:231], v[108:123]
    v_rcp_f32 v211, v211
    v_exp_f32 v212, v212
    v_exp_f32_e64 v213, v213
    v_mfma_f32_32x32x16_bf16 v[124:139], v[248:251], v[228:231], v[124:139]
    v_exp_f32 v214, v214
    v_exp_f32 v215, v215
    v_exp_f32_e64 v216, v216
    v_mfma_f32_32x32x16_bf16 v[140:155], v[252:255], v[228:231], v[140:155]
    v_exp_f32 v217, v217
    v_exp_f32 v218, v218
    v_exp_f32 v219, v219
    s_setprio 2
    v_mul_f32 v204, v204, v180
    v_mul_f32 v205, v205, v181
    v_mul_f32 v206, v206, v182
    v_mul_f32 v207, v207, v183
    v_mul_f32 v208, v208, v184
    v_mul_f32 v209, v209, v185
    v_mul_f32 v210, v210, v186
    v_mul_f32 v211, v211, v187
    v_add_f32 v212, 1.0, v212
    v_add_f32 v213, 1.0, v213
    v_add_f32 v214, 1.0, v214
    v_add_f32 v215, 1.0, v215
    v_add_f32 v216, 1.0, v216
    v_add_f32 v217, 1.0, v217
    v_add_f32 v218, 1.0, v218
    v_add_f32 v219, 1.0, v219
    v_fma_f32 v220, -v196, v196, s30
    v_fma_f32 v221, -v197, v197, s30
    v_fma_f32 v222, -v198, v198, s30
    v_fma_f32 v223, -v199, v199, s30
    v_fma_f32 v224, -v200, v200, s30
    v_fma_f32 v225, -v201, v201, s30
    v_fma_f32 v226, -v202, v202, s30
    v_fma_f32 v227, -v203, v203, s30
    v_mul_f32 v220, v220, v196
    v_mul_f32 v221, v221, v197
    v_mul_f32 v222, v222, v198
    v_mul_f32 v223, v223, v199
    v_mul_f32 v224, v224, v200
    v_mul_f32 v225, v225, v201
    v_mul_f32 v226, v226, v202
    v_mul_f32 v227, v227, v203
    ds_read_b64_tr_b16 v[232:233], v1 offset:21504
    ds_read_b64_tr_b16 v[234:235], v1 offset:21760
    ds_read_b64_tr_b16 v[236:237], v1 offset:22528
    ds_read_b64_tr_b16 v[238:239], v1 offset:22784
    ds_read_b64_tr_b16 v[240:241], v1 offset:23552
    ds_read_b64_tr_b16 v[242:243], v1 offset:23808
    ds_read_b64_tr_b16 v[244:245], v3 offset:9216
    ds_read_b64_tr_b16 v[246:247], v3 offset:9728
    ds_read_b64_tr_b16 v[248:249], v3 offset:10240
    ds_read_b64_tr_b16 v[250:251], v3 offset:10752
    ds_read_b64_tr_b16 v[252:253], v3 offset:11264
    ds_read_b64_tr_b16 v[254:255], v3 offset:11776
    ds_read_b128 v[180:183], v5 offset:576
    ds_read_b128 v[184:187], v5 offset:608
    buffer_store_dwordx4 v[76:79], v10, s[8:11], s28 offen offset:128 nt
    s_setprio 1
    s_waitcnt lgkmcnt(8)
    v_mfma_f32_32x32x16_bf16 v[156:171], v[232:235], v[48:51], v[156:171]
    v_cvt_pk_bf16_f32 v228, v204, v205
    v_cvt_pk_bf16_f32 v229, v206, v207
    v_cvt_pk_bf16_f32 v230, v208, v209
    v_cvt_pk_bf16_f32 v231, v210, v211
    v_rcp_f32_e64 v212, v212
    v_mfma_f32_32x32x16_bf16 v[156:171], v[236:239], v[52:55], v[156:171]
    v_rcp_f32 v213, v213
    v_rcp_f32 v214, v214
    v_rcp_f32_e64 v215, v215
    v_mfma_f32_32x32x16_bf16 v[156:171], v[240:243], v[56:59], v[156:171]
    v_rcp_f32 v216, v216
    v_rcp_f32 v217, v217
    v_rcp_f32 v218, v218
    s_waitcnt lgkmcnt(0)
    v_mfma_f32_32x32x16_bf16 v[108:123], v[244:247], v[228:231], v[108:123]
    v_rcp_f32 v219, v219
    v_exp_f32 v220, v220
    v_exp_f32_e64 v221, v221
    v_mfma_f32_32x32x16_bf16 v[124:139], v[248:251], v[228:231], v[124:139]
    v_exp_f32 v222, v222
    v_exp_f32 v223, v223
    v_exp_f32_e64 v224, v224
    v_mfma_f32_32x32x16_bf16 v[140:155], v[252:255], v[228:231], v[140:155]
    v_exp_f32 v225, v225
    v_exp_f32 v226, v226
    v_exp_f32 v227, v227
    s_setprio 2
    v_mul_f32 v212, v212, v188
    v_mul_f32 v213, v213, v189
    v_mul_f32 v214, v214, v190
    v_mul_f32 v215, v215, v191
    v_mul_f32 v216, v216, v192
    v_mul_f32 v217, v217, v193
    v_mul_f32 v218, v218, v194
    v_mul_f32 v219, v219, v195
    v_add_f32 v220, 1.0, v220
    v_add_f32 v221, 1.0, v221
    v_add_f32 v222, 1.0, v222
    v_add_f32 v223, 1.0, v223
    v_add_f32 v224, 1.0, v224
    v_add_f32 v225, 1.0, v225
    v_add_f32 v226, 1.0, v226
    v_add_f32 v227, 1.0, v227
    v_fma_f32 v204, -v156, v156, s30
    v_fma_f32 v205, -v157, v157, s30
    v_fma_f32 v206, -v158, v158, s30
    v_fma_f32 v207, -v159, v159, s30
    v_fma_f32 v208, -v160, v160, s30
    v_fma_f32 v209, -v161, v161, s30
    v_fma_f32 v210, -v162, v162, s30
    v_fma_f32 v211, -v163, v163, s30
    v_mul_f32 v204, v204, v156
    v_mul_f32 v205, v205, v157
    v_mul_f32 v206, v206, v158
    v_mul_f32 v207, v207, v159
    v_mul_f32 v208, v208, v160
    v_mul_f32 v209, v209, v161
    v_mul_f32 v210, v210, v162
    v_mul_f32 v211, v211, v163
    ds_read_b64_tr_b16 v[232:233], v1 offset:24576
    ds_read_b64_tr_b16 v[234:235], v1 offset:24832
    ds_read_b64_tr_b16 v[236:237], v1 offset:25600
    ds_read_b64_tr_b16 v[238:239], v1 offset:25856
    ds_read_b64_tr_b16 v[240:241], v1 offset:26624
    ds_read_b64_tr_b16 v[242:243], v1 offset:26880
    ds_read_b64_tr_b16 v[244:245], v3 offset:12288
    ds_read_b64_tr_b16 v[246:247], v3 offset:12800
    ds_read_b64_tr_b16 v[248:249], v3 offset:13312
    ds_read_b64_tr_b16 v[250:251], v3 offset:13824
    ds_read_b64_tr_b16 v[252:253], v3 offset:14336
    ds_read_b64_tr_b16 v[254:255], v3 offset:14848
    ds_read_b128 v[188:191], v5 offset:640
    ds_read_b128 v[192:195], v5 offset:672
    buffer_store_dwordx4 v[80:83], v10, s[8:11], s28 offen offset:320 nt
    s_setprio 1
    s_waitcnt lgkmcnt(8)
    v_mfma_f32_32x32x16_bf16 v[172:187], v[232:235], v[36:39], v[172:187]
    v_cvt_pk_bf16_f32 v228, v212, v213
    v_cvt_pk_bf16_f32 v229, v214, v215
    v_cvt_pk_bf16_f32 v230, v216, v217
    v_cvt_pk_bf16_f32 v231, v218, v219
    v_rcp_f32_e64 v220, v220
    v_mfma_f32_32x32x16_bf16 v[172:187], v[236:239], v[40:43], v[172:187]
    v_rcp_f32 v221, v221
    v_rcp_f32 v222, v222
    v_rcp_f32_e64 v223, v223
    v_mfma_f32_32x32x16_bf16 v[172:187], v[240:243], v[44:47], v[172:187]
    v_rcp_f32 v224, v224
    v_rcp_f32 v225, v225
    v_rcp_f32 v226, v226
    s_waitcnt lgkmcnt(0)
    v_mfma_f32_32x32x16_bf16 v[108:123], v[244:247], v[228:231], v[108:123]
    v_rcp_f32 v227, v227
    v_exp_f32 v204, v204
    v_exp_f32_e64 v205, v205
    v_mfma_f32_32x32x16_bf16 v[124:139], v[248:251], v[228:231], v[124:139]
    v_exp_f32 v206, v206
    v_exp_f32 v207, v207
    v_exp_f32_e64 v208, v208
    v_mfma_f32_32x32x16_bf16 v[140:155], v[252:255], v[228:231], v[140:155]
    v_exp_f32 v209, v209
    v_exp_f32 v210, v210
    v_exp_f32 v211, v211
    s_setprio 2
    v_mul_f32 v220, v220, v196
    v_mul_f32 v221, v221, v197
    v_mul_f32 v222, v222, v198
    v_mul_f32 v223, v223, v199
    v_mul_f32 v224, v224, v200
    v_mul_f32 v225, v225, v201
    v_mul_f32 v226, v226, v202
    v_mul_f32 v227, v227, v203
    v_add_f32 v204, 1.0, v204
    v_add_f32 v205, 1.0, v205
    v_add_f32 v206, 1.0, v206
    v_add_f32 v207, 1.0, v207
    v_add_f32 v208, 1.0, v208
    v_add_f32 v209, 1.0, v209
    v_add_f32 v210, 1.0, v210
    v_add_f32 v211, 1.0, v211
    v_fma_f32 v212, -v164, v164, s30
    v_fma_f32 v213, -v165, v165, s30
    v_fma_f32 v214, -v166, v166, s30
    v_fma_f32 v215, -v167, v167, s30
    v_fma_f32 v216, -v168, v168, s30
    v_fma_f32 v217, -v169, v169, s30
    v_fma_f32 v218, -v170, v170, s30
    v_fma_f32 v219, -v171, v171, s30
    v_mul_f32 v212, v212, v164
    v_mul_f32 v213, v213, v165
    v_mul_f32 v214, v214, v166
    v_mul_f32 v215, v215, v167
    v_mul_f32 v216, v216, v168
    v_mul_f32 v217, v217, v169
    v_mul_f32 v218, v218, v170
    v_mul_f32 v219, v219, v171
    ds_read_b64_tr_b16 v[232:233], v1 offset:27648
    ds_read_b64_tr_b16 v[234:235], v1 offset:27904
    ds_read_b64_tr_b16 v[236:237], v1 offset:28672
    ds_read_b64_tr_b16 v[238:239], v1 offset:28928
    ds_read_b64_tr_b16 v[240:241], v1 offset:29696
    ds_read_b64_tr_b16 v[242:243], v1 offset:29952
    ds_read_b64_tr_b16 v[244:245], v3 offset:15360
    ds_read_b64_tr_b16 v[246:247], v3 offset:15872
    ds_read_b64_tr_b16 v[248:249], v3 offset:16384
    ds_read_b64_tr_b16 v[250:251], v3 offset:16896
    ds_read_b64_tr_b16 v[252:253], v3 offset:17408
    ds_read_b64_tr_b16 v[254:255], v3 offset:17920
    ds_read_b128 v[196:199], v5 offset:704
    ds_read_b128 v[200:203], v5 offset:736
    s_setprio 1
    s_waitcnt lgkmcnt(8)
    v_mfma_f32_32x32x16_bf16 v[172:187], v[232:235], v[48:51], v[172:187]
    v_cvt_pk_bf16_f32 v228, v220, v221
    v_cvt_pk_bf16_f32 v229, v222, v223
    v_cvt_pk_bf16_f32 v230, v224, v225
    v_cvt_pk_bf16_f32 v231, v226, v227
    v_rcp_f32_e64 v204, v204
    v_mfma_f32_32x32x16_bf16 v[172:187], v[236:239], v[52:55], v[172:187]
    v_rcp_f32 v205, v205
    v_rcp_f32 v206, v206
    v_rcp_f32_e64 v207, v207
    v_mfma_f32_32x32x16_bf16 v[172:187], v[240:243], v[56:59], v[172:187]
    v_rcp_f32 v208, v208
    v_rcp_f32 v209, v209
    v_rcp_f32 v210, v210
    s_waitcnt lgkmcnt(0)
    v_mfma_f32_32x32x16_bf16 v[108:123], v[244:247], v[228:231], v[108:123]
    v_rcp_f32 v211, v211
    v_exp_f32 v212, v212
    v_exp_f32_e64 v213, v213
    v_mfma_f32_32x32x16_bf16 v[124:139], v[248:251], v[228:231], v[124:139]
    v_exp_f32 v214, v214
    v_exp_f32 v215, v215
    v_exp_f32_e64 v216, v216
    v_mfma_f32_32x32x16_bf16 v[140:155], v[252:255], v[228:231], v[140:155]
    v_exp_f32 v217, v217
    v_exp_f32 v218, v218
    v_exp_f32 v219, v219
    s_setprio 2
    v_mul_f32 v204, v204, v156
    v_mul_f32 v205, v205, v157
    v_mul_f32 v206, v206, v158
    v_mul_f32 v207, v207, v159
    v_mul_f32 v208, v208, v160
    v_mul_f32 v209, v209, v161
    v_mul_f32 v210, v210, v162
    v_mul_f32 v211, v211, v163
    v_add_f32 v212, 1.0, v212
    v_add_f32 v213, 1.0, v213
    v_add_f32 v214, 1.0, v214
    v_add_f32 v215, 1.0, v215
    v_add_f32 v216, 1.0, v216
    v_add_f32 v217, 1.0, v217
    v_add_f32 v218, 1.0, v218
    v_add_f32 v219, 1.0, v219
    v_fma_f32 v220, -v172, v172, s30
    v_fma_f32 v221, -v173, v173, s30
    v_fma_f32 v222, -v174, v174, s30
    v_fma_f32 v223, -v175, v175, s30
    v_fma_f32 v224, -v176, v176, s30
    v_fma_f32 v225, -v177, v177, s30
    v_fma_f32 v226, -v178, v178, s30
    v_fma_f32 v227, -v179, v179, s30
    v_mul_f32 v220, v220, v172
    v_mul_f32 v221, v221, v173
    v_mul_f32 v222, v222, v174
    v_mul_f32 v223, v223, v175
    v_mul_f32 v224, v224, v176
    v_mul_f32 v225, v225, v177
    v_mul_f32 v226, v226, v178
    v_mul_f32 v227, v227, v179
    ds_read_b64_tr_b16 v[232:233], v1 offset:30720
    ds_read_b64_tr_b16 v[234:235], v1 offset:30976
    ds_read_b64_tr_b16 v[236:237], v1 offset:31744
    ds_read_b64_tr_b16 v[238:239], v1 offset:32000
    ds_read_b64_tr_b16 v[240:241], v1 offset:32768
    ds_read_b64_tr_b16 v[242:243], v1 offset:33024
    ds_read_b64_tr_b16 v[244:245], v3 offset:18432
    ds_read_b64_tr_b16 v[246:247], v3 offset:18944
    ds_read_b64_tr_b16 v[248:249], v3 offset:19456
    ds_read_b64_tr_b16 v[250:251], v3 offset:19968
    ds_read_b64_tr_b16 v[252:253], v3 offset:20480
    ds_read_b64_tr_b16 v[254:255], v3 offset:20992
    ds_read_b128 v[156:159], v5 offset:768
    ds_read_b128 v[160:163], v5 offset:800
    s_setprio 1
    s_waitcnt lgkmcnt(8)
    v_mfma_f32_32x32x16_bf16 v[188:203], v[232:235], v[36:39], v[188:203]
    v_cvt_pk_bf16_f32 v228, v204, v205
    v_cvt_pk_bf16_f32 v229, v206, v207
    v_cvt_pk_bf16_f32 v230, v208, v209
    v_cvt_pk_bf16_f32 v231, v210, v211
    v_rcp_f32_e64 v212, v212
    v_mfma_f32_32x32x16_bf16 v[188:203], v[236:239], v[40:43], v[188:203]
    v_rcp_f32 v213, v213
    v_rcp_f32 v214, v214
    v_rcp_f32_e64 v215, v215
    v_mfma_f32_32x32x16_bf16 v[188:203], v[240:243], v[44:47], v[188:203]
    v_rcp_f32 v216, v216
    v_rcp_f32 v217, v217
    v_rcp_f32 v218, v218
    s_waitcnt lgkmcnt(0)
    v_mfma_f32_32x32x16_bf16 v[108:123], v[244:247], v[228:231], v[108:123]
    v_rcp_f32 v219, v219
    v_exp_f32 v220, v220
    v_exp_f32_e64 v221, v221
    v_mfma_f32_32x32x16_bf16 v[124:139], v[248:251], v[228:231], v[124:139]
    v_exp_f32 v222, v222
    v_exp_f32 v223, v223
    v_exp_f32_e64 v224, v224
    v_mfma_f32_32x32x16_bf16 v[140:155], v[252:255], v[228:231], v[140:155]
    v_exp_f32 v225, v225
    v_exp_f32 v226, v226
    v_exp_f32 v227, v227
    s_setprio 2
    s_waitcnt vmcnt(4)
    s_barrier
    v_mul_f32 v212, v212, v164
    v_mul_f32 v213, v213, v165
    v_mul_f32 v214, v214, v166
    v_mul_f32 v215, v215, v167
    v_mul_f32 v216, v216, v168
    v_mul_f32 v217, v217, v169
    v_mul_f32 v218, v218, v170
    v_mul_f32 v219, v219, v171
    v_add_f32 v220, 1.0, v220
    v_add_f32 v221, 1.0, v221
    v_add_f32 v222, 1.0, v222
    v_add_f32 v223, 1.0, v223
    v_add_f32 v224, 1.0, v224
    v_add_f32 v225, 1.0, v225
    v_add_f32 v226, 1.0, v226
    v_add_f32 v227, 1.0, v227
    v_fma_f32 v204, -v180, v180, s30
    v_fma_f32 v205, -v181, v181, s30
    v_fma_f32 v206, -v182, v182, s30
    v_fma_f32 v207, -v183, v183, s30
    v_fma_f32 v208, -v184, v184, s30
    v_fma_f32 v209, -v185, v185, s30
    v_fma_f32 v210, -v186, v186, s30
    v_fma_f32 v211, -v187, v187, s30
    v_mul_f32 v204, v204, v180
    v_mul_f32 v205, v205, v181
    v_mul_f32 v206, v206, v182
    v_mul_f32 v207, v207, v183
    v_mul_f32 v208, v208, v184
    v_mul_f32 v209, v209, v185
    v_mul_f32 v210, v210, v186
    v_mul_f32 v211, v211, v187
    ds_read_b64_tr_b16 v[232:233], v1 offset:33792
    ds_read_b64_tr_b16 v[234:235], v1 offset:34048
    ds_read_b64_tr_b16 v[236:237], v1 offset:34816
    ds_read_b64_tr_b16 v[238:239], v1 offset:35072
    ds_read_b64_tr_b16 v[240:241], v1 offset:35840
    ds_read_b64_tr_b16 v[242:243], v1 offset:36096
    ds_read_b64_tr_b16 v[244:245], v3 offset:21504
    ds_read_b64_tr_b16 v[246:247], v3 offset:22016
    ds_read_b64_tr_b16 v[248:249], v3 offset:22528
    ds_read_b64_tr_b16 v[250:251], v3 offset:23040
    ds_read_b64_tr_b16 v[252:253], v3 offset:23552
    ds_read_b64_tr_b16 v[254:255], v3 offset:24064
    ds_read_b128 v[164:167], v5 offset:832
    ds_read_b128 v[168:171], v5 offset:864
    s_setprio 1
    s_waitcnt lgkmcnt(8)
    v_mfma_f32_32x32x16_bf16 v[188:203], v[232:235], v[48:51], v[188:203]
    v_cvt_pk_bf16_f32 v228, v212, v213
    v_cvt_pk_bf16_f32 v229, v214, v215
    v_cvt_pk_bf16_f32 v230, v216, v217
    v_cvt_pk_bf16_f32 v231, v218, v219
    v_rcp_f32_e64 v220, v220
    v_mfma_f32_32x32x16_bf16 v[188:203], v[236:239], v[52:55], v[188:203]
    v_rcp_f32 v221, v221
    v_rcp_f32 v222, v222
    v_rcp_f32_e64 v223, v223
    v_mfma_f32_32x32x16_bf16 v[188:203], v[240:243], v[56:59], v[188:203]
    v_rcp_f32 v224, v224
    v_rcp_f32 v225, v225
    v_rcp_f32 v226, v226
    s_waitcnt lgkmcnt(0)
    v_mfma_f32_32x32x16_bf16 v[108:123], v[244:247], v[228:231], v[108:123]
    v_rcp_f32 v227, v227
    v_exp_f32 v204, v204
    v_exp_f32_e64 v205, v205
    v_mfma_f32_32x32x16_bf16 v[124:139], v[248:251], v[228:231], v[124:139]
    v_exp_f32 v206, v206
    v_exp_f32 v207, v207
    v_exp_f32_e64 v208, v208
    v_mfma_f32_32x32x16_bf16 v[140:155], v[252:255], v[228:231], v[140:155]
    v_exp_f32 v209, v209
    v_exp_f32 v210, v210
    v_exp_f32 v211, v211
    s_setprio 2
    v_mov_b32 v60, v84
    v_mov_b32 v61, v85
    v_mov_b32 v62, v86
    v_mov_b32 v63, v87
    v_mov_b32 v64, v88
    v_mov_b32 v65, v89
    v_mov_b32 v66, v90
    v_mov_b32 v67, v91
    v_mul_f32 v220, v220, v172
    v_mul_f32 v221, v221, v173
    v_mul_f32 v222, v222, v174
    v_mul_f32 v223, v223, v175
    v_mul_f32 v224, v224, v176
    v_mul_f32 v225, v225, v177
    v_mul_f32 v226, v226, v178
    v_mul_f32 v227, v227, v179
    v_add_f32 v204, 1.0, v204
    v_add_f32 v205, 1.0, v205
    v_add_f32 v206, 1.0, v206
    v_add_f32 v207, 1.0, v207
    v_add_f32 v208, 1.0, v208
    v_add_f32 v209, 1.0, v209
    v_add_f32 v210, 1.0, v210
    v_add_f32 v211, 1.0, v211
    v_fma_f32 v212, -v188, v188, s30
    v_fma_f32 v213, -v189, v189, s30
    v_fma_f32 v214, -v190, v190, s30
    v_fma_f32 v215, -v191, v191, s30
    v_fma_f32 v216, -v192, v192, s30
    v_fma_f32 v217, -v193, v193, s30
    v_fma_f32 v218, -v194, v194, s30
    v_fma_f32 v219, -v195, v195, s30
    v_mul_f32 v212, v212, v188
    v_mul_f32 v213, v213, v189
    v_mul_f32 v214, v214, v190
    v_mul_f32 v215, v215, v191
    v_mul_f32 v216, v216, v192
    v_mul_f32 v217, v217, v193
    v_mul_f32 v218, v218, v194
    v_mul_f32 v219, v219, v195
    ds_read_b64_tr_b16 v[232:233], v2 offset:0
    ds_read_b64_tr_b16 v[234:235], v2 offset:256
    ds_read_b64_tr_b16 v[236:237], v2 offset:1024
    ds_read_b64_tr_b16 v[238:239], v2 offset:1280
    ds_read_b64_tr_b16 v[240:241], v2 offset:2048
    ds_read_b64_tr_b16 v[242:243], v2 offset:2304
    ds_read_b64_tr_b16 v[244:245], v3 offset:24576
    ds_read_b64_tr_b16 v[246:247], v3 offset:25088
    ds_read_b64_tr_b16 v[248:249], v3 offset:25600
    ds_read_b64_tr_b16 v[250:251], v3 offset:26112
    ds_read_b64_tr_b16 v[252:253], v3 offset:26624
    ds_read_b64_tr_b16 v[254:255], v3 offset:27136
    ds_read_b128 v[172:175], v5 offset:896
    ds_read_b128 v[176:179], v5 offset:928
    buffer_load_dwordx4 v[84:87], v7, s[4:7], s27 offen offset:0
    s_setprio 1
    s_waitcnt lgkmcnt(8)
    v_mfma_f32_32x32x16_bf16 v[156:171], v[232:235], v[36:39], v[156:171]
    v_cvt_pk_bf16_f32 v228, v220, v221
    v_cvt_pk_bf16_f32 v229, v222, v223
    v_cvt_pk_bf16_f32 v230, v224, v225
    v_cvt_pk_bf16_f32 v231, v226, v227
    v_rcp_f32_e64 v204, v204
    v_mfma_f32_32x32x16_bf16 v[156:171], v[236:239], v[40:43], v[156:171]
    v_rcp_f32 v205, v205
    v_rcp_f32 v206, v206
    v_rcp_f32_e64 v207, v207
    v_mfma_f32_32x32x16_bf16 v[156:171], v[240:243], v[44:47], v[156:171]
    v_rcp_f32 v208, v208
    v_rcp_f32 v209, v209
    v_rcp_f32 v210, v210
    s_waitcnt lgkmcnt(0)
    v_mfma_f32_32x32x16_bf16 v[108:123], v[244:247], v[228:231], v[108:123]
    v_rcp_f32 v211, v211
    v_exp_f32 v212, v212
    v_exp_f32_e64 v213, v213
    v_mfma_f32_32x32x16_bf16 v[124:139], v[248:251], v[228:231], v[124:139]
    v_exp_f32 v214, v214
    v_exp_f32 v215, v215
    v_exp_f32_e64 v216, v216
    v_mfma_f32_32x32x16_bf16 v[140:155], v[252:255], v[228:231], v[140:155]
    v_exp_f32 v217, v217
    v_exp_f32 v218, v218
    v_exp_f32 v219, v219
    s_setprio 2
    v_mul_f32 v204, v204, v180
    v_mul_f32 v205, v205, v181
    v_mul_f32 v206, v206, v182
    v_mul_f32 v207, v207, v183
    v_mul_f32 v208, v208, v184
    v_mul_f32 v209, v209, v185
    v_mul_f32 v210, v210, v186
    v_mul_f32 v211, v211, v187
    v_add_f32 v212, 1.0, v212
    v_add_f32 v213, 1.0, v213
    v_add_f32 v214, 1.0, v214
    v_add_f32 v215, 1.0, v215
    v_add_f32 v216, 1.0, v216
    v_add_f32 v217, 1.0, v217
    v_add_f32 v218, 1.0, v218
    v_add_f32 v219, 1.0, v219
    v_fma_f32 v220, -v196, v196, s30
    v_fma_f32 v221, -v197, v197, s30
    v_fma_f32 v222, -v198, v198, s30
    v_fma_f32 v223, -v199, v199, s30
    v_fma_f32 v224, -v200, v200, s30
    v_fma_f32 v225, -v201, v201, s30
    v_fma_f32 v226, -v202, v202, s30
    v_fma_f32 v227, -v203, v203, s30
    v_mul_f32 v220, v220, v196
    v_mul_f32 v221, v221, v197
    v_mul_f32 v222, v222, v198
    v_mul_f32 v223, v223, v199
    v_mul_f32 v224, v224, v200
    v_mul_f32 v225, v225, v201
    v_mul_f32 v226, v226, v202
    v_mul_f32 v227, v227, v203
    ds_read_b64_tr_b16 v[232:233], v2 offset:3072
    ds_read_b64_tr_b16 v[234:235], v2 offset:3328
    ds_read_b64_tr_b16 v[236:237], v2 offset:4096
    ds_read_b64_tr_b16 v[238:239], v2 offset:4352
    ds_read_b64_tr_b16 v[240:241], v2 offset:5120
    ds_read_b64_tr_b16 v[242:243], v2 offset:5376
    ds_read_b64_tr_b16 v[244:245], v3 offset:27648
    ds_read_b64_tr_b16 v[246:247], v3 offset:28160
    ds_read_b64_tr_b16 v[248:249], v3 offset:28672
    ds_read_b64_tr_b16 v[250:251], v3 offset:29184
    ds_read_b64_tr_b16 v[252:253], v3 offset:29696
    ds_read_b64_tr_b16 v[254:255], v3 offset:30208
    ds_read_b128 v[180:183], v5 offset:960
    ds_read_b128 v[184:187], v5 offset:992
    s_setprio 1
    s_waitcnt lgkmcnt(8)
    v_mfma_f32_32x32x16_bf16 v[156:171], v[232:235], v[48:51], v[156:171]
    v_cvt_pk_bf16_f32 v228, v204, v205
    v_cvt_pk_bf16_f32 v229, v206, v207
    v_cvt_pk_bf16_f32 v230, v208, v209
    v_cvt_pk_bf16_f32 v231, v210, v211
    v_rcp_f32_e64 v212, v212
    v_mfma_f32_32x32x16_bf16 v[156:171], v[236:239], v[52:55], v[156:171]
    v_rcp_f32 v213, v213
    v_rcp_f32 v214, v214
    v_rcp_f32_e64 v215, v215
    v_mfma_f32_32x32x16_bf16 v[156:171], v[240:243], v[56:59], v[156:171]
    v_rcp_f32 v216, v216
    v_rcp_f32 v217, v217
    v_rcp_f32 v218, v218
    s_waitcnt lgkmcnt(0)
    v_mfma_f32_32x32x16_bf16 v[108:123], v[244:247], v[228:231], v[108:123]
    v_rcp_f32 v219, v219
    v_exp_f32 v220, v220
    v_exp_f32_e64 v221, v221
    v_mfma_f32_32x32x16_bf16 v[124:139], v[248:251], v[228:231], v[124:139]
    v_exp_f32 v222, v222
    v_exp_f32 v223, v223
    v_exp_f32_e64 v224, v224
    v_mfma_f32_32x32x16_bf16 v[140:155], v[252:255], v[228:231], v[140:155]
    v_exp_f32 v225, v225
    v_exp_f32 v226, v226
    v_exp_f32 v227, v227
    s_setprio 2
    v_mul_f32 v212, v212, v188
    v_mul_f32 v213, v213, v189
    v_mul_f32 v214, v214, v190
    v_mul_f32 v215, v215, v191
    v_mul_f32 v216, v216, v192
    v_mul_f32 v217, v217, v193
    v_mul_f32 v218, v218, v194
    v_mul_f32 v219, v219, v195
    v_add_f32 v220, 1.0, v220
    v_add_f32 v221, 1.0, v221
    v_add_f32 v222, 1.0, v222
    v_add_f32 v223, 1.0, v223
    v_add_f32 v224, 1.0, v224
    v_add_f32 v225, 1.0, v225
    v_add_f32 v226, 1.0, v226
    v_add_f32 v227, 1.0, v227
    v_fma_f32 v204, -v156, v156, s30
    v_fma_f32 v205, -v157, v157, s30
    v_fma_f32 v206, -v158, v158, s30
    v_fma_f32 v207, -v159, v159, s30
    v_fma_f32 v208, -v160, v160, s30
    v_fma_f32 v209, -v161, v161, s30
    v_fma_f32 v210, -v162, v162, s30
    v_fma_f32 v211, -v163, v163, s30
    v_mul_f32 v204, v204, v156
    v_mul_f32 v205, v205, v157
    v_mul_f32 v206, v206, v158
    v_mul_f32 v207, v207, v159
    v_mul_f32 v208, v208, v160
    v_mul_f32 v209, v209, v161
    v_mul_f32 v210, v210, v162
    v_mul_f32 v211, v211, v163
    ds_read_b64_tr_b16 v[232:233], v2 offset:6144
    ds_read_b64_tr_b16 v[234:235], v2 offset:6400
    ds_read_b64_tr_b16 v[236:237], v2 offset:7168
    ds_read_b64_tr_b16 v[238:239], v2 offset:7424
    ds_read_b64_tr_b16 v[240:241], v2 offset:8192
    ds_read_b64_tr_b16 v[242:243], v2 offset:8448
    ds_read_b64_tr_b16 v[244:245], v3 offset:30720
    ds_read_b64_tr_b16 v[246:247], v3 offset:31232
    ds_read_b64_tr_b16 v[248:249], v3 offset:31744
    ds_read_b64_tr_b16 v[250:251], v3 offset:32256
    ds_read_b64_tr_b16 v[252:253], v3 offset:32768
    ds_read_b64_tr_b16 v[254:255], v3 offset:33280
    ds_read_b128 v[188:191], v5 offset:1024
    ds_read_b128 v[192:195], v5 offset:1056
    s_setprio 1
    s_waitcnt lgkmcnt(8)
    v_mfma_f32_32x32x16_bf16 v[172:187], v[232:235], v[36:39], v[172:187]
    v_cvt_pk_bf16_f32 v228, v212, v213
    v_cvt_pk_bf16_f32 v229, v214, v215
    v_cvt_pk_bf16_f32 v230, v216, v217
    v_cvt_pk_bf16_f32 v231, v218, v219
    v_rcp_f32_e64 v220, v220
    v_mfma_f32_32x32x16_bf16 v[172:187], v[236:239], v[40:43], v[172:187]
    v_rcp_f32 v221, v221
    v_rcp_f32 v222, v222
    v_rcp_f32_e64 v223, v223
    v_mfma_f32_32x32x16_bf16 v[172:187], v[240:243], v[44:47], v[172:187]
    v_rcp_f32 v224, v224
    v_rcp_f32 v225, v225
    v_rcp_f32 v226, v226
    s_waitcnt lgkmcnt(0)
    v_mfma_f32_32x32x16_bf16 v[108:123], v[244:247], v[228:231], v[108:123]
    v_rcp_f32 v227, v227
    v_exp_f32 v204, v204
    v_exp_f32_e64 v205, v205
    v_mfma_f32_32x32x16_bf16 v[124:139], v[248:251], v[228:231], v[124:139]
    v_exp_f32 v206, v206
    v_exp_f32 v207, v207
    v_exp_f32_e64 v208, v208
    v_mfma_f32_32x32x16_bf16 v[140:155], v[252:255], v[228:231], v[140:155]
    v_exp_f32 v209, v209
    v_exp_f32 v210, v210
    v_exp_f32 v211, v211
    s_setprio 2
    v_mul_f32 v220, v220, v196
    v_mul_f32 v221, v221, v197
    v_mul_f32 v222, v222, v198
    v_mul_f32 v223, v223, v199
    v_mul_f32 v224, v224, v200
    v_mul_f32 v225, v225, v201
    v_mul_f32 v226, v226, v202
    v_mul_f32 v227, v227, v203
    v_add_f32 v204, 1.0, v204
    v_add_f32 v205, 1.0, v205
    v_add_f32 v206, 1.0, v206
    v_add_f32 v207, 1.0, v207
    v_add_f32 v208, 1.0, v208
    v_add_f32 v209, 1.0, v209
    v_add_f32 v210, 1.0, v210
    v_add_f32 v211, 1.0, v211
    v_fma_f32 v212, -v164, v164, s30
    v_fma_f32 v213, -v165, v165, s30
    v_fma_f32 v214, -v166, v166, s30
    v_fma_f32 v215, -v167, v167, s30
    v_fma_f32 v216, -v168, v168, s30
    v_fma_f32 v217, -v169, v169, s30
    v_fma_f32 v218, -v170, v170, s30
    v_fma_f32 v219, -v171, v171, s30
    v_mul_f32 v212, v212, v164
    v_mul_f32 v213, v213, v165
    v_mul_f32 v214, v214, v166
    v_mul_f32 v215, v215, v167
    v_mul_f32 v216, v216, v168
    v_mul_f32 v217, v217, v169
    v_mul_f32 v218, v218, v170
    v_mul_f32 v219, v219, v171
    ds_read_b64_tr_b16 v[232:233], v2 offset:9216
    ds_read_b64_tr_b16 v[234:235], v2 offset:9472
    ds_read_b64_tr_b16 v[236:237], v2 offset:10240
    ds_read_b64_tr_b16 v[238:239], v2 offset:10496
    ds_read_b64_tr_b16 v[240:241], v2 offset:11264
    ds_read_b64_tr_b16 v[242:243], v2 offset:11520
    ds_read_b64_tr_b16 v[244:245], v3 offset:33792
    ds_read_b64_tr_b16 v[246:247], v3 offset:34304
    ds_read_b64_tr_b16 v[248:249], v3 offset:34816
    ds_read_b64_tr_b16 v[250:251], v3 offset:35328
    ds_read_b64_tr_b16 v[252:253], v3 offset:35840
    ds_read_b64_tr_b16 v[254:255], v3 offset:36352
    ds_read_b128 v[196:199], v5 offset:1088
    ds_read_b128 v[200:203], v5 offset:1120
    s_setprio 1
    s_waitcnt lgkmcnt(8)
    v_mfma_f32_32x32x16_bf16 v[172:187], v[232:235], v[48:51], v[172:187]
    v_cvt_pk_bf16_f32 v228, v220, v221
    v_cvt_pk_bf16_f32 v229, v222, v223
    v_cvt_pk_bf16_f32 v230, v224, v225
    v_cvt_pk_bf16_f32 v231, v226, v227
    v_rcp_f32_e64 v204, v204
    v_mfma_f32_32x32x16_bf16 v[172:187], v[236:239], v[52:55], v[172:187]
    v_rcp_f32 v205, v205
    v_rcp_f32 v206, v206
    v_rcp_f32_e64 v207, v207
    v_mfma_f32_32x32x16_bf16 v[172:187], v[240:243], v[56:59], v[172:187]
    v_rcp_f32 v208, v208
    v_rcp_f32 v209, v209
    v_rcp_f32 v210, v210
    s_waitcnt lgkmcnt(0)
    v_mfma_f32_32x32x16_bf16 v[108:123], v[244:247], v[228:231], v[108:123]
    v_rcp_f32 v211, v211
    v_exp_f32 v212, v212
    v_exp_f32_e64 v213, v213
    v_mfma_f32_32x32x16_bf16 v[124:139], v[248:251], v[228:231], v[124:139]
    v_exp_f32 v214, v214
    v_exp_f32 v215, v215
    v_exp_f32_e64 v216, v216
    v_mfma_f32_32x32x16_bf16 v[140:155], v[252:255], v[228:231], v[140:155]
    v_exp_f32 v217, v217
    v_exp_f32 v218, v218
    v_exp_f32 v219, v219
    s_setprio 2
    v_mul_f32 v204, v204, v156
    v_mul_f32 v205, v205, v157
    v_mul_f32 v206, v206, v158
    v_mul_f32 v207, v207, v159
    v_mul_f32 v208, v208, v160
    v_mul_f32 v209, v209, v161
    v_mul_f32 v210, v210, v162
    v_mul_f32 v211, v211, v163
    v_add_f32 v212, 1.0, v212
    v_add_f32 v213, 1.0, v213
    v_add_f32 v214, 1.0, v214
    v_add_f32 v215, 1.0, v215
    v_add_f32 v216, 1.0, v216
    v_add_f32 v217, 1.0, v217
    v_add_f32 v218, 1.0, v218
    v_add_f32 v219, 1.0, v219
    v_fma_f32 v220, -v172, v172, s30
    v_fma_f32 v221, -v173, v173, s30
    v_fma_f32 v222, -v174, v174, s30
    v_fma_f32 v223, -v175, v175, s30
    v_fma_f32 v224, -v176, v176, s30
    v_fma_f32 v225, -v177, v177, s30
    v_fma_f32 v226, -v178, v178, s30
    v_fma_f32 v227, -v179, v179, s30
    v_mul_f32 v220, v220, v172
    v_mul_f32 v221, v221, v173
    v_mul_f32 v222, v222, v174
    v_mul_f32 v223, v223, v175
    v_mul_f32 v224, v224, v176
    v_mul_f32 v225, v225, v177
    v_mul_f32 v226, v226, v178
    v_mul_f32 v227, v227, v179
    ds_read_b64_tr_b16 v[232:233], v2 offset:12288
    ds_read_b64_tr_b16 v[234:235], v2 offset:12544
    ds_read_b64_tr_b16 v[236:237], v2 offset:13312
    ds_read_b64_tr_b16 v[238:239], v2 offset:13568
    ds_read_b64_tr_b16 v[240:241], v2 offset:14336
    ds_read_b64_tr_b16 v[242:243], v2 offset:14592
    ds_read_b64_tr_b16 v[244:245], v4 offset:0
    ds_read_b64_tr_b16 v[246:247], v4 offset:512
    ds_read_b64_tr_b16 v[248:249], v4 offset:1024
    ds_read_b64_tr_b16 v[250:251], v4 offset:1536
    ds_read_b64_tr_b16 v[252:253], v4 offset:2048
    ds_read_b64_tr_b16 v[254:255], v4 offset:2560
    ds_read_b128 v[156:159], v5 offset:1152
    ds_read_b128 v[160:163], v5 offset:1184
    buffer_load_dwordx4 v[88:91], v7, s[4:7], s27 offen offset:32
    s_setprio 1
    s_waitcnt lgkmcnt(8)
    v_mfma_f32_32x32x16_bf16 v[188:203], v[232:235], v[36:39], v[188:203]
    v_cvt_pk_bf16_f32 v228, v204, v205
    v_cvt_pk_bf16_f32 v229, v206, v207
    v_cvt_pk_bf16_f32 v230, v208, v209
    v_cvt_pk_bf16_f32 v231, v210, v211
    v_rcp_f32_e64 v212, v212
    v_mfma_f32_32x32x16_bf16 v[188:203], v[236:239], v[40:43], v[188:203]
    v_rcp_f32 v213, v213
    v_rcp_f32 v214, v214
    v_rcp_f32_e64 v215, v215
    v_mfma_f32_32x32x16_bf16 v[188:203], v[240:243], v[44:47], v[188:203]
    v_rcp_f32 v216, v216
    v_rcp_f32 v217, v217
    v_rcp_f32 v218, v218
    s_waitcnt lgkmcnt(0)
    v_mfma_f32_32x32x16_bf16 v[108:123], v[244:247], v[228:231], v[108:123]
    v_rcp_f32 v219, v219
    v_exp_f32 v220, v220
    v_exp_f32_e64 v221, v221
    v_mfma_f32_32x32x16_bf16 v[124:139], v[248:251], v[228:231], v[124:139]
    v_exp_f32 v222, v222
    v_exp_f32 v223, v223
    v_exp_f32_e64 v224, v224
    v_mfma_f32_32x32x16_bf16 v[140:155], v[252:255], v[228:231], v[140:155]
    v_exp_f32 v225, v225
    v_exp_f32 v226, v226
    v_exp_f32 v227, v227
    s_setprio 2
    v_mov_b32 v68, v92
    v_mov_b32 v69, v93
    v_mov_b32 v70, v94
    v_mov_b32 v71, v95
    v_mov_b32 v72, v96
    v_mov_b32 v73, v97
    v_mov_b32 v74, v98
    v_mov_b32 v75, v99
    v_mul_f32 v212, v212, v164
    v_mul_f32 v213, v213, v165
    v_mul_f32 v214, v214, v166
    v_mul_f32 v215, v215, v167
    v_mul_f32 v216, v216, v168
    v_mul_f32 v217, v217, v169
    v_mul_f32 v218, v218, v170
    v_mul_f32 v219, v219, v171
    v_add_f32 v220, 1.0, v220
    v_add_f32 v221, 1.0, v221
    v_add_f32 v222, 1.0, v222
    v_add_f32 v223, 1.0, v223
    v_add_f32 v224, 1.0, v224
    v_add_f32 v225, 1.0, v225
    v_add_f32 v226, 1.0, v226
    v_add_f32 v227, 1.0, v227
    v_fma_f32 v204, -v180, v180, s30
    v_fma_f32 v205, -v181, v181, s30
    v_fma_f32 v206, -v182, v182, s30
    v_fma_f32 v207, -v183, v183, s30
    v_fma_f32 v208, -v184, v184, s30
    v_fma_f32 v209, -v185, v185, s30
    v_fma_f32 v210, -v186, v186, s30
    v_fma_f32 v211, -v187, v187, s30
    v_mul_f32 v204, v204, v180
    v_mul_f32 v205, v205, v181
    v_mul_f32 v206, v206, v182
    v_mul_f32 v207, v207, v183
    v_mul_f32 v208, v208, v184
    v_mul_f32 v209, v209, v185
    v_mul_f32 v210, v210, v186
    v_mul_f32 v211, v211, v187
    ds_read_b64_tr_b16 v[232:233], v2 offset:15360
    ds_read_b64_tr_b16 v[234:235], v2 offset:15616
    ds_read_b64_tr_b16 v[236:237], v2 offset:16384
    ds_read_b64_tr_b16 v[238:239], v2 offset:16640
    ds_read_b64_tr_b16 v[240:241], v2 offset:17408
    ds_read_b64_tr_b16 v[242:243], v2 offset:17664
    ds_read_b64_tr_b16 v[244:245], v4 offset:3072
    ds_read_b64_tr_b16 v[246:247], v4 offset:3584
    ds_read_b64_tr_b16 v[248:249], v4 offset:4096
    ds_read_b64_tr_b16 v[250:251], v4 offset:4608
    ds_read_b64_tr_b16 v[252:253], v4 offset:5120
    ds_read_b64_tr_b16 v[254:255], v4 offset:5632
    ds_read_b128 v[164:167], v5 offset:1216
    ds_read_b128 v[168:171], v5 offset:1248
    buffer_load_dwordx4 v[92:95], v7, s[4:7], s27 offen offset:64
    s_setprio 1
    s_waitcnt lgkmcnt(8)
    v_mfma_f32_32x32x16_bf16 v[188:203], v[232:235], v[48:51], v[188:203]
    v_cvt_pk_bf16_f32 v228, v212, v213
    v_cvt_pk_bf16_f32 v229, v214, v215
    v_cvt_pk_bf16_f32 v230, v216, v217
    v_cvt_pk_bf16_f32 v231, v218, v219
    v_rcp_f32_e64 v220, v220
    v_mfma_f32_32x32x16_bf16 v[188:203], v[236:239], v[52:55], v[188:203]
    v_rcp_f32 v221, v221
    v_rcp_f32 v222, v222
    v_rcp_f32_e64 v223, v223
    v_mfma_f32_32x32x16_bf16 v[188:203], v[240:243], v[56:59], v[188:203]
    v_rcp_f32 v224, v224
    v_rcp_f32 v225, v225
    v_rcp_f32 v226, v226
    s_waitcnt lgkmcnt(0)
    v_mfma_f32_32x32x16_bf16 v[108:123], v[244:247], v[228:231], v[108:123]
    v_rcp_f32 v227, v227
    v_exp_f32 v204, v204
    v_exp_f32_e64 v205, v205
    v_mfma_f32_32x32x16_bf16 v[124:139], v[248:251], v[228:231], v[124:139]
    v_exp_f32 v206, v206
    v_exp_f32 v207, v207
    v_exp_f32_e64 v208, v208
    v_mfma_f32_32x32x16_bf16 v[140:155], v[252:255], v[228:231], v[140:155]
    v_exp_f32 v209, v209
    v_exp_f32 v210, v210
    v_exp_f32 v211, v211
    s_setprio 2
    v_mul_f32 v220, v220, v172
    v_mul_f32 v221, v221, v173
    v_mul_f32 v222, v222, v174
    v_mul_f32 v223, v223, v175
    v_mul_f32 v224, v224, v176
    v_mul_f32 v225, v225, v177
    v_mul_f32 v226, v226, v178
    v_mul_f32 v227, v227, v179
    v_add_f32 v204, 1.0, v204
    v_add_f32 v205, 1.0, v205
    v_add_f32 v206, 1.0, v206
    v_add_f32 v207, 1.0, v207
    v_add_f32 v208, 1.0, v208
    v_add_f32 v209, 1.0, v209
    v_add_f32 v210, 1.0, v210
    v_add_f32 v211, 1.0, v211
    v_fma_f32 v212, -v188, v188, s30
    v_fma_f32 v213, -v189, v189, s30
    v_fma_f32 v214, -v190, v190, s30
    v_fma_f32 v215, -v191, v191, s30
    v_fma_f32 v216, -v192, v192, s30
    v_fma_f32 v217, -v193, v193, s30
    v_fma_f32 v218, -v194, v194, s30
    v_fma_f32 v219, -v195, v195, s30
    v_mul_f32 v212, v212, v188
    v_mul_f32 v213, v213, v189
    v_mul_f32 v214, v214, v190
    v_mul_f32 v215, v215, v191
    v_mul_f32 v216, v216, v192
    v_mul_f32 v217, v217, v193
    v_mul_f32 v218, v218, v194
    v_mul_f32 v219, v219, v195
    ds_read_b64_tr_b16 v[232:233], v2 offset:18432
    ds_read_b64_tr_b16 v[234:235], v2 offset:18688
    ds_read_b64_tr_b16 v[236:237], v2 offset:19456
    ds_read_b64_tr_b16 v[238:239], v2 offset:19712
    ds_read_b64_tr_b16 v[240:241], v2 offset:20480
    ds_read_b64_tr_b16 v[242:243], v2 offset:20736
    ds_read_b64_tr_b16 v[244:245], v4 offset:6144
    ds_read_b64_tr_b16 v[246:247], v4 offset:6656
    ds_read_b64_tr_b16 v[248:249], v4 offset:7168
    ds_read_b64_tr_b16 v[250:251], v4 offset:7680
    ds_read_b64_tr_b16 v[252:253], v4 offset:8192
    ds_read_b64_tr_b16 v[254:255], v4 offset:8704
    ds_read_b128 v[172:175], v5 offset:1280
    ds_read_b128 v[176:179], v5 offset:1312
    s_setprio 1
    s_waitcnt lgkmcnt(8)
    v_mfma_f32_32x32x16_bf16 v[156:171], v[232:235], v[36:39], v[156:171]
    v_cvt_pk_bf16_f32 v228, v220, v221
    v_cvt_pk_bf16_f32 v229, v222, v223
    v_cvt_pk_bf16_f32 v230, v224, v225
    v_cvt_pk_bf16_f32 v231, v226, v227
    v_rcp_f32_e64 v204, v204
    v_mfma_f32_32x32x16_bf16 v[156:171], v[236:239], v[40:43], v[156:171]
    v_rcp_f32 v205, v205
    v_rcp_f32 v206, v206
    v_rcp_f32_e64 v207, v207
    v_mfma_f32_32x32x16_bf16 v[156:171], v[240:243], v[44:47], v[156:171]
    v_rcp_f32 v208, v208
    v_rcp_f32 v209, v209
    v_rcp_f32 v210, v210
    s_waitcnt lgkmcnt(0)
    v_mfma_f32_32x32x16_bf16 v[108:123], v[244:247], v[228:231], v[108:123]
    v_rcp_f32 v211, v211
    v_exp_f32 v212, v212
    v_exp_f32_e64 v213, v213
    v_mfma_f32_32x32x16_bf16 v[124:139], v[248:251], v[228:231], v[124:139]
    v_exp_f32 v214, v214
    v_exp_f32 v215, v215
    v_exp_f32_e64 v216, v216
    v_mfma_f32_32x32x16_bf16 v[140:155], v[252:255], v[228:231], v[140:155]
    v_exp_f32 v217, v217
    v_exp_f32 v218, v218
    v_exp_f32 v219, v219
    s_setprio 2
    v_mul_f32 v204, v204, v180
    v_mul_f32 v205, v205, v181
    v_mul_f32 v206, v206, v182
    v_mul_f32 v207, v207, v183
    v_mul_f32 v208, v208, v184
    v_mul_f32 v209, v209, v185
    v_mul_f32 v210, v210, v186
    v_mul_f32 v211, v211, v187
    v_add_f32 v212, 1.0, v212
    v_add_f32 v213, 1.0, v213
    v_add_f32 v214, 1.0, v214
    v_add_f32 v215, 1.0, v215
    v_add_f32 v216, 1.0, v216
    v_add_f32 v217, 1.0, v217
    v_add_f32 v218, 1.0, v218
    v_add_f32 v219, 1.0, v219
    v_fma_f32 v220, -v196, v196, s30
    v_fma_f32 v221, -v197, v197, s30
    v_fma_f32 v222, -v198, v198, s30
    v_fma_f32 v223, -v199, v199, s30
    v_fma_f32 v224, -v200, v200, s30
    v_fma_f32 v225, -v201, v201, s30
    v_fma_f32 v226, -v202, v202, s30
    v_fma_f32 v227, -v203, v203, s30
    v_mul_f32 v220, v220, v196
    v_mul_f32 v221, v221, v197
    v_mul_f32 v222, v222, v198
    v_mul_f32 v223, v223, v199
    v_mul_f32 v224, v224, v200
    v_mul_f32 v225, v225, v201
    v_mul_f32 v226, v226, v202
    v_mul_f32 v227, v227, v203
    ds_read_b64_tr_b16 v[232:233], v2 offset:21504
    ds_read_b64_tr_b16 v[234:235], v2 offset:21760
    ds_read_b64_tr_b16 v[236:237], v2 offset:22528
    ds_read_b64_tr_b16 v[238:239], v2 offset:22784
    ds_read_b64_tr_b16 v[240:241], v2 offset:23552
    ds_read_b64_tr_b16 v[242:243], v2 offset:23808
    ds_read_b64_tr_b16 v[244:245], v4 offset:9216
    ds_read_b64_tr_b16 v[246:247], v4 offset:9728
    ds_read_b64_tr_b16 v[248:249], v4 offset:10240
    ds_read_b64_tr_b16 v[250:251], v4 offset:10752
    ds_read_b64_tr_b16 v[252:253], v4 offset:11264
    ds_read_b64_tr_b16 v[254:255], v4 offset:11776
    ds_read_b128 v[180:183], v5 offset:1344
    ds_read_b128 v[184:187], v5 offset:1376
    s_setprio 1
    s_waitcnt lgkmcnt(8)
    v_mfma_f32_32x32x16_bf16 v[156:171], v[232:235], v[48:51], v[156:171]
    v_cvt_pk_bf16_f32 v228, v204, v205
    v_cvt_pk_bf16_f32 v229, v206, v207
    v_cvt_pk_bf16_f32 v230, v208, v209
    v_cvt_pk_bf16_f32 v231, v210, v211
    v_rcp_f32_e64 v212, v212
    v_mfma_f32_32x32x16_bf16 v[156:171], v[236:239], v[52:55], v[156:171]
    v_rcp_f32 v213, v213
    v_rcp_f32 v214, v214
    v_rcp_f32_e64 v215, v215
    v_mfma_f32_32x32x16_bf16 v[156:171], v[240:243], v[56:59], v[156:171]
    v_rcp_f32 v216, v216
    v_rcp_f32 v217, v217
    v_rcp_f32 v218, v218
    s_waitcnt lgkmcnt(0)
    v_mfma_f32_32x32x16_bf16 v[108:123], v[244:247], v[228:231], v[108:123]
    v_rcp_f32 v219, v219
    v_exp_f32 v220, v220
    v_exp_f32_e64 v221, v221
    v_mfma_f32_32x32x16_bf16 v[124:139], v[248:251], v[228:231], v[124:139]
    v_exp_f32 v222, v222
    v_exp_f32 v223, v223
    v_exp_f32_e64 v224, v224
    v_mfma_f32_32x32x16_bf16 v[140:155], v[252:255], v[228:231], v[140:155]
    v_exp_f32 v225, v225
    v_exp_f32 v226, v226
    v_exp_f32 v227, v227
    s_setprio 2
    v_mul_f32 v212, v212, v188
    v_mul_f32 v213, v213, v189
    v_mul_f32 v214, v214, v190
    v_mul_f32 v215, v215, v191
    v_mul_f32 v216, v216, v192
    v_mul_f32 v217, v217, v193
    v_mul_f32 v218, v218, v194
    v_mul_f32 v219, v219, v195
    v_add_f32 v220, 1.0, v220
    v_add_f32 v221, 1.0, v221
    v_add_f32 v222, 1.0, v222
    v_add_f32 v223, 1.0, v223
    v_add_f32 v224, 1.0, v224
    v_add_f32 v225, 1.0, v225
    v_add_f32 v226, 1.0, v226
    v_add_f32 v227, 1.0, v227
    v_fma_f32 v204, -v156, v156, s30
    v_fma_f32 v205, -v157, v157, s30
    v_fma_f32 v206, -v158, v158, s30
    v_fma_f32 v207, -v159, v159, s30
    v_fma_f32 v208, -v160, v160, s30
    v_fma_f32 v209, -v161, v161, s30
    v_fma_f32 v210, -v162, v162, s30
    v_fma_f32 v211, -v163, v163, s30
    v_mul_f32 v204, v204, v156
    v_mul_f32 v205, v205, v157
    v_mul_f32 v206, v206, v158
    v_mul_f32 v207, v207, v159
    v_mul_f32 v208, v208, v160
    v_mul_f32 v209, v209, v161
    v_mul_f32 v210, v210, v162
    v_mul_f32 v211, v211, v163
    ds_read_b64_tr_b16 v[232:233], v2 offset:24576
    ds_read_b64_tr_b16 v[234:235], v2 offset:24832
    ds_read_b64_tr_b16 v[236:237], v2 offset:25600
    ds_read_b64_tr_b16 v[238:239], v2 offset:25856
    ds_read_b64_tr_b16 v[240:241], v2 offset:26624
    ds_read_b64_tr_b16 v[242:243], v2 offset:26880
    ds_read_b64_tr_b16 v[244:245], v4 offset:12288
    ds_read_b64_tr_b16 v[246:247], v4 offset:12800
    ds_read_b64_tr_b16 v[248:249], v4 offset:13312
    ds_read_b64_tr_b16 v[250:251], v4 offset:13824
    ds_read_b64_tr_b16 v[252:253], v4 offset:14336
    ds_read_b64_tr_b16 v[254:255], v4 offset:14848
    ds_read_b128 v[188:191], v5 offset:1408
    ds_read_b128 v[192:195], v5 offset:1440
    s_setprio 1
    s_waitcnt lgkmcnt(8)
    v_mfma_f32_32x32x16_bf16 v[172:187], v[232:235], v[36:39], v[172:187]
    v_cvt_pk_bf16_f32 v228, v212, v213
    v_cvt_pk_bf16_f32 v229, v214, v215
    v_cvt_pk_bf16_f32 v230, v216, v217
    v_cvt_pk_bf16_f32 v231, v218, v219
    v_rcp_f32_e64 v220, v220
    v_mfma_f32_32x32x16_bf16 v[172:187], v[236:239], v[40:43], v[172:187]
    v_rcp_f32 v221, v221
    v_rcp_f32 v222, v222
    v_rcp_f32_e64 v223, v223
    v_mfma_f32_32x32x16_bf16 v[172:187], v[240:243], v[44:47], v[172:187]
    v_rcp_f32 v224, v224
    v_rcp_f32 v225, v225
    v_rcp_f32 v226, v226
    s_waitcnt lgkmcnt(0)
    v_mfma_f32_32x32x16_bf16 v[108:123], v[244:247], v[228:231], v[108:123]
    v_rcp_f32 v227, v227
    v_exp_f32 v204, v204
    v_exp_f32_e64 v205, v205
    v_mfma_f32_32x32x16_bf16 v[124:139], v[248:251], v[228:231], v[124:139]
    v_exp_f32 v206, v206
    v_exp_f32 v207, v207
    v_exp_f32_e64 v208, v208
    v_mfma_f32_32x32x16_bf16 v[140:155], v[252:255], v[228:231], v[140:155]
    v_exp_f32 v209, v209
    v_exp_f32 v210, v210
    v_exp_f32 v211, v211
    s_setprio 2
    v_mul_f32 v220, v220, v196
    v_mul_f32 v221, v221, v197
    v_mul_f32 v222, v222, v198
    v_mul_f32 v223, v223, v199
    v_mul_f32 v224, v224, v200
    v_mul_f32 v225, v225, v201
    v_mul_f32 v226, v226, v202
    v_mul_f32 v227, v227, v203
    v_add_f32 v204, 1.0, v204
    v_add_f32 v205, 1.0, v205
    v_add_f32 v206, 1.0, v206
    v_add_f32 v207, 1.0, v207
    v_add_f32 v208, 1.0, v208
    v_add_f32 v209, 1.0, v209
    v_add_f32 v210, 1.0, v210
    v_add_f32 v211, 1.0, v211
    v_fma_f32 v212, -v164, v164, s30
    v_fma_f32 v213, -v165, v165, s30
    v_fma_f32 v214, -v166, v166, s30
    v_fma_f32 v215, -v167, v167, s30
    v_fma_f32 v216, -v168, v168, s30
    v_fma_f32 v217, -v169, v169, s30
    v_fma_f32 v218, -v170, v170, s30
    v_fma_f32 v219, -v171, v171, s30
    v_mul_f32 v212, v212, v164
    v_mul_f32 v213, v213, v165
    v_mul_f32 v214, v214, v166
    v_mul_f32 v215, v215, v167
    v_mul_f32 v216, v216, v168
    v_mul_f32 v217, v217, v169
    v_mul_f32 v218, v218, v170
    v_mul_f32 v219, v219, v171
    ds_read_b64_tr_b16 v[232:233], v2 offset:27648
    ds_read_b64_tr_b16 v[234:235], v2 offset:27904
    ds_read_b64_tr_b16 v[236:237], v2 offset:28672
    ds_read_b64_tr_b16 v[238:239], v2 offset:28928
    ds_read_b64_tr_b16 v[240:241], v2 offset:29696
    ds_read_b64_tr_b16 v[242:243], v2 offset:29952
    ds_read_b64_tr_b16 v[244:245], v4 offset:15360
    ds_read_b64_tr_b16 v[246:247], v4 offset:15872
    ds_read_b64_tr_b16 v[248:249], v4 offset:16384
    ds_read_b64_tr_b16 v[250:251], v4 offset:16896
    ds_read_b64_tr_b16 v[252:253], v4 offset:17408
    ds_read_b64_tr_b16 v[254:255], v4 offset:17920
    ds_read_b128 v[196:199], v5 offset:1472
    ds_read_b128 v[200:203], v5 offset:1504
    buffer_load_dwordx4 v[96:99], v7, s[4:7], s27 offen offset:96
    s_setprio 1
    s_waitcnt lgkmcnt(8)
    v_mfma_f32_32x32x16_bf16 v[172:187], v[232:235], v[48:51], v[172:187]
    v_cvt_pk_bf16_f32 v228, v220, v221
    v_cvt_pk_bf16_f32 v229, v222, v223
    v_cvt_pk_bf16_f32 v230, v224, v225
    v_cvt_pk_bf16_f32 v231, v226, v227
    v_rcp_f32_e64 v204, v204
    v_mfma_f32_32x32x16_bf16 v[172:187], v[236:239], v[52:55], v[172:187]
    v_rcp_f32 v205, v205
    v_rcp_f32 v206, v206
    v_rcp_f32_e64 v207, v207
    v_mfma_f32_32x32x16_bf16 v[172:187], v[240:243], v[56:59], v[172:187]
    v_rcp_f32 v208, v208
    v_rcp_f32 v209, v209
    v_rcp_f32 v210, v210
    s_waitcnt lgkmcnt(0)
    v_mfma_f32_32x32x16_bf16 v[108:123], v[244:247], v[228:231], v[108:123]
    v_rcp_f32 v211, v211
    v_exp_f32 v212, v212
    v_exp_f32_e64 v213, v213
    v_mfma_f32_32x32x16_bf16 v[124:139], v[248:251], v[228:231], v[124:139]
    v_exp_f32 v214, v214
    v_exp_f32 v215, v215
    v_exp_f32_e64 v216, v216
    v_mfma_f32_32x32x16_bf16 v[140:155], v[252:255], v[228:231], v[140:155]
    v_exp_f32 v217, v217
    v_exp_f32 v218, v218
    v_exp_f32 v219, v219
    s_setprio 2
    v_mov_b32 v76, v100
    v_mov_b32 v77, v101
    v_mov_b32 v78, v102
    v_mov_b32 v79, v103
    v_mov_b32 v80, v104
    v_mov_b32 v81, v105
    v_mov_b32 v82, v106
    v_mov_b32 v83, v107
    v_mul_f32 v204, v204, v156
    v_mul_f32 v205, v205, v157
    v_mul_f32 v206, v206, v158
    v_mul_f32 v207, v207, v159
    v_mul_f32 v208, v208, v160
    v_mul_f32 v209, v209, v161
    v_mul_f32 v210, v210, v162
    v_mul_f32 v211, v211, v163
    v_add_f32 v212, 1.0, v212
    v_add_f32 v213, 1.0, v213
    v_add_f32 v214, 1.0, v214
    v_add_f32 v215, 1.0, v215
    v_add_f32 v216, 1.0, v216
    v_add_f32 v217, 1.0, v217
    v_add_f32 v218, 1.0, v218
    v_add_f32 v219, 1.0, v219
    v_fma_f32 v220, -v172, v172, s30
    v_fma_f32 v221, -v173, v173, s30
    v_fma_f32 v222, -v174, v174, s30
    v_fma_f32 v223, -v175, v175, s30
    v_fma_f32 v224, -v176, v176, s30
    v_fma_f32 v225, -v177, v177, s30
    v_fma_f32 v226, -v178, v178, s30
    v_fma_f32 v227, -v179, v179, s30
    v_mul_f32 v220, v220, v172
    v_mul_f32 v221, v221, v173
    v_mul_f32 v222, v222, v174
    v_mul_f32 v223, v223, v175
    v_mul_f32 v224, v224, v176
    v_mul_f32 v225, v225, v177
    v_mul_f32 v226, v226, v178
    v_mul_f32 v227, v227, v179
    ds_read_b64_tr_b16 v[232:233], v2 offset:30720
    ds_read_b64_tr_b16 v[234:235], v2 offset:30976
    ds_read_b64_tr_b16 v[236:237], v2 offset:31744
    ds_read_b64_tr_b16 v[238:239], v2 offset:32000
    ds_read_b64_tr_b16 v[240:241], v2 offset:32768
    ds_read_b64_tr_b16 v[242:243], v2 offset:33024
    ds_read_b64_tr_b16 v[244:245], v4 offset:18432
    ds_read_b64_tr_b16 v[246:247], v4 offset:18944
    ds_read_b64_tr_b16 v[248:249], v4 offset:19456
    ds_read_b64_tr_b16 v[250:251], v4 offset:19968
    ds_read_b64_tr_b16 v[252:253], v4 offset:20480
    ds_read_b64_tr_b16 v[254:255], v4 offset:20992
    buffer_load_dwordx4 v[100:103], v7, s[4:7], s27 offen offset:128
    s_setprio 1
    s_waitcnt lgkmcnt(6)
    v_mfma_f32_32x32x16_bf16 v[188:203], v[232:235], v[36:39], v[188:203]
    v_cvt_pk_bf16_f32 v228, v204, v205
    v_cvt_pk_bf16_f32 v229, v206, v207
    v_cvt_pk_bf16_f32 v230, v208, v209
    v_cvt_pk_bf16_f32 v231, v210, v211
    v_rcp_f32_e64 v212, v212
    v_mfma_f32_32x32x16_bf16 v[188:203], v[236:239], v[40:43], v[188:203]
    v_rcp_f32 v213, v213
    v_rcp_f32 v214, v214
    v_rcp_f32_e64 v215, v215
    v_mfma_f32_32x32x16_bf16 v[188:203], v[240:243], v[44:47], v[188:203]
    v_rcp_f32 v216, v216
    v_rcp_f32 v217, v217
    v_rcp_f32 v218, v218
    s_waitcnt lgkmcnt(0)
    v_mfma_f32_32x32x16_bf16 v[108:123], v[244:247], v[228:231], v[108:123]
    v_rcp_f32 v219, v219
    v_exp_f32 v220, v220
    v_exp_f32_e64 v221, v221
    v_mfma_f32_32x32x16_bf16 v[124:139], v[248:251], v[228:231], v[124:139]
    v_exp_f32 v222, v222
    v_exp_f32 v223, v223
    v_exp_f32_e64 v224, v224
    v_mfma_f32_32x32x16_bf16 v[140:155], v[252:255], v[228:231], v[140:155]
    v_exp_f32 v225, v225
    v_exp_f32 v226, v226
    v_exp_f32 v227, v227
    s_setprio 2
    v_mul_f32 v212, v212, v164
    v_mul_f32 v213, v213, v165
    v_mul_f32 v214, v214, v166
    v_mul_f32 v215, v215, v167
    v_mul_f32 v216, v216, v168
    v_mul_f32 v217, v217, v169
    v_mul_f32 v218, v218, v170
    v_mul_f32 v219, v219, v171
    v_add_f32 v220, 1.0, v220
    v_add_f32 v221, 1.0, v221
    v_add_f32 v222, 1.0, v222
    v_add_f32 v223, 1.0, v223
    v_add_f32 v224, 1.0, v224
    v_add_f32 v225, 1.0, v225
    v_add_f32 v226, 1.0, v226
    v_add_f32 v227, 1.0, v227
    v_fma_f32 v204, -v180, v180, s30
    v_fma_f32 v205, -v181, v181, s30
    v_fma_f32 v206, -v182, v182, s30
    v_fma_f32 v207, -v183, v183, s30
    v_fma_f32 v208, -v184, v184, s30
    v_fma_f32 v209, -v185, v185, s30
    v_fma_f32 v210, -v186, v186, s30
    v_fma_f32 v211, -v187, v187, s30
    v_mul_f32 v204, v204, v180
    v_mul_f32 v205, v205, v181
    v_mul_f32 v206, v206, v182
    v_mul_f32 v207, v207, v183
    v_mul_f32 v208, v208, v184
    v_mul_f32 v209, v209, v185
    v_mul_f32 v210, v210, v186
    v_mul_f32 v211, v211, v187
    ds_read_b64_tr_b16 v[232:233], v2 offset:33792
    ds_read_b64_tr_b16 v[234:235], v2 offset:34048
    ds_read_b64_tr_b16 v[236:237], v2 offset:34816
    ds_read_b64_tr_b16 v[238:239], v2 offset:35072
    ds_read_b64_tr_b16 v[240:241], v2 offset:35840
    ds_read_b64_tr_b16 v[242:243], v2 offset:36096
    ds_read_b64_tr_b16 v[244:245], v4 offset:21504
    ds_read_b64_tr_b16 v[246:247], v4 offset:22016
    ds_read_b64_tr_b16 v[248:249], v4 offset:22528
    ds_read_b64_tr_b16 v[250:251], v4 offset:23040
    ds_read_b64_tr_b16 v[252:253], v4 offset:23552
    ds_read_b64_tr_b16 v[254:255], v4 offset:24064
    s_setprio 1
    s_waitcnt lgkmcnt(6)
    v_mfma_f32_32x32x16_bf16 v[188:203], v[232:235], v[48:51], v[188:203]
    v_cvt_pk_bf16_f32 v228, v212, v213
    v_cvt_pk_bf16_f32 v229, v214, v215
    v_cvt_pk_bf16_f32 v230, v216, v217
    v_cvt_pk_bf16_f32 v231, v218, v219
    v_rcp_f32_e64 v220, v220
    v_mfma_f32_32x32x16_bf16 v[188:203], v[236:239], v[52:55], v[188:203]
    v_rcp_f32 v221, v221
    v_rcp_f32 v222, v222
    v_rcp_f32_e64 v223, v223
    v_mfma_f32_32x32x16_bf16 v[188:203], v[240:243], v[56:59], v[188:203]
    v_rcp_f32 v224, v224
    v_rcp_f32 v225, v225
    v_rcp_f32 v226, v226
    s_waitcnt lgkmcnt(0)
    v_mfma_f32_32x32x16_bf16 v[108:123], v[244:247], v[228:231], v[108:123]
    v_rcp_f32 v227, v227
    v_exp_f32 v204, v204
    v_exp_f32_e64 v205, v205
    v_mfma_f32_32x32x16_bf16 v[124:139], v[248:251], v[228:231], v[124:139]
    v_exp_f32 v206, v206
    v_exp_f32 v207, v207
    v_exp_f32_e64 v208, v208
    v_mfma_f32_32x32x16_bf16 v[140:155], v[252:255], v[228:231], v[140:155]
    v_exp_f32 v209, v209
    v_exp_f32 v210, v210
    v_exp_f32 v211, v211
    s_setprio 2
    v_mul_f32 v220, v220, v172
    v_mul_f32 v221, v221, v173
    v_mul_f32 v222, v222, v174
    v_mul_f32 v223, v223, v175
    v_mul_f32 v224, v224, v176
    v_mul_f32 v225, v225, v177
    v_mul_f32 v226, v226, v178
    v_mul_f32 v227, v227, v179
    v_add_f32 v204, 1.0, v204
    v_add_f32 v205, 1.0, v205
    v_add_f32 v206, 1.0, v206
    v_add_f32 v207, 1.0, v207
    v_add_f32 v208, 1.0, v208
    v_add_f32 v209, 1.0, v209
    v_add_f32 v210, 1.0, v210
    v_add_f32 v211, 1.0, v211
    v_fma_f32 v212, -v188, v188, s30
    v_fma_f32 v213, -v189, v189, s30
    v_fma_f32 v214, -v190, v190, s30
    v_fma_f32 v215, -v191, v191, s30
    v_fma_f32 v216, -v192, v192, s30
    v_fma_f32 v217, -v193, v193, s30
    v_fma_f32 v218, -v194, v194, s30
    v_fma_f32 v219, -v195, v195, s30
    v_mul_f32 v212, v212, v188
    v_mul_f32 v213, v213, v189
    v_mul_f32 v214, v214, v190
    v_mul_f32 v215, v215, v191
    v_mul_f32 v216, v216, v192
    v_mul_f32 v217, v217, v193
    v_mul_f32 v218, v218, v194
    v_mul_f32 v219, v219, v195
    ds_read_b64_tr_b16 v[244:245], v4 offset:24576
    ds_read_b64_tr_b16 v[246:247], v4 offset:25088
    ds_read_b64_tr_b16 v[248:249], v4 offset:25600
    ds_read_b64_tr_b16 v[250:251], v4 offset:26112
    ds_read_b64_tr_b16 v[252:253], v4 offset:26624
    ds_read_b64_tr_b16 v[254:255], v4 offset:27136
    s_setprio 1
    s_waitcnt lgkmcnt(0)
    v_cvt_pk_bf16_f32 v228, v220, v221
    v_cvt_pk_bf16_f32 v229, v222, v223
    v_cvt_pk_bf16_f32 v230, v224, v225
    v_cvt_pk_bf16_f32 v231, v226, v227
    s_nop 1
    v_mfma_f32_32x32x16_bf16 v[108:123], v[244:247], v[228:231], v[108:123]
    v_rcp_f32 v204, v204
    v_rcp_f32 v205, v205
    v_rcp_f32 v206, v206
    v_rcp_f32 v207, v207
    v_rcp_f32 v208, v208
    v_rcp_f32_e64 v209, v209
    v_mfma_f32_32x32x16_bf16 v[124:139], v[248:251], v[228:231], v[124:139]
    v_rcp_f32 v210, v210
    v_rcp_f32 v211, v211
    v_exp_f32 v212, v212
    v_exp_f32 v213, v213
    v_exp_f32_e64 v214, v214
    v_mfma_f32_32x32x16_bf16 v[140:155], v[252:255], v[228:231], v[140:155]
    v_exp_f32 v215, v215
    v_exp_f32 v216, v216
    v_exp_f32 v217, v217
    v_exp_f32 v218, v218
    v_exp_f32 v219, v219
    s_setprio 2
    v_mul_f32 v204, v204, v180
    v_mul_f32 v205, v205, v181
    v_mul_f32 v206, v206, v182
    v_mul_f32 v207, v207, v183
    v_mul_f32 v208, v208, v184
    v_mul_f32 v209, v209, v185
    v_mul_f32 v210, v210, v186
    v_mul_f32 v211, v211, v187
    v_add_f32 v212, 1.0, v212
    v_add_f32 v213, 1.0, v213
    v_add_f32 v214, 1.0, v214
    v_add_f32 v215, 1.0, v215
    v_add_f32 v216, 1.0, v216
    v_add_f32 v217, 1.0, v217
    v_add_f32 v218, 1.0, v218
    v_add_f32 v219, 1.0, v219
    v_fma_f32 v220, -v196, v196, s30
    v_fma_f32 v221, -v197, v197, s30
    v_fma_f32 v222, -v198, v198, s30
    v_fma_f32 v223, -v199, v199, s30
    v_fma_f32 v224, -v200, v200, s30
    v_fma_f32 v225, -v201, v201, s30
    v_fma_f32 v226, -v202, v202, s30
    v_fma_f32 v227, -v203, v203, s30
    v_mul_f32 v220, v220, v196
    v_mul_f32 v221, v221, v197
    v_mul_f32 v222, v222, v198
    v_mul_f32 v223, v223, v199
    v_mul_f32 v224, v224, v200
    v_mul_f32 v225, v225, v201
    v_mul_f32 v226, v226, v202
    v_mul_f32 v227, v227, v203
    ds_read_b64_tr_b16 v[244:245], v4 offset:27648
    ds_read_b64_tr_b16 v[246:247], v4 offset:28160
    ds_read_b64_tr_b16 v[248:249], v4 offset:28672
    ds_read_b64_tr_b16 v[250:251], v4 offset:29184
    ds_read_b64_tr_b16 v[252:253], v4 offset:29696
    ds_read_b64_tr_b16 v[254:255], v4 offset:30208
    buffer_load_dwordx4 v[104:107], v7, s[4:7], s27 offen offset:160
    s_setprio 1
    s_waitcnt lgkmcnt(0)
    v_cvt_pk_bf16_f32 v228, v204, v205
    v_cvt_pk_bf16_f32 v229, v206, v207
    v_cvt_pk_bf16_f32 v230, v208, v209
    v_cvt_pk_bf16_f32 v231, v210, v211
    s_nop 1
    v_mfma_f32_32x32x16_bf16 v[108:123], v[244:247], v[228:231], v[108:123]
    v_rcp_f32 v212, v212
    v_rcp_f32 v213, v213
    v_rcp_f32 v214, v214
    v_rcp_f32 v215, v215
    v_rcp_f32 v216, v216
    v_rcp_f32_e64 v217, v217
    v_mfma_f32_32x32x16_bf16 v[124:139], v[248:251], v[228:231], v[124:139]
    v_rcp_f32 v218, v218
    v_rcp_f32 v219, v219
    v_exp_f32 v220, v220
    v_exp_f32 v221, v221
    v_exp_f32_e64 v222, v222
    v_mfma_f32_32x32x16_bf16 v[140:155], v[252:255], v[228:231], v[140:155]
    v_exp_f32 v223, v223
    v_exp_f32 v224, v224
    v_exp_f32 v225, v225
    v_exp_f32 v226, v226
    v_exp_f32 v227, v227
    s_setprio 2
    v_mul_f32 v212, v212, v188
    v_mul_f32 v213, v213, v189
    v_mul_f32 v214, v214, v190
    v_mul_f32 v215, v215, v191
    v_mul_f32 v216, v216, v192
    v_mul_f32 v217, v217, v193
    v_mul_f32 v218, v218, v194
    v_mul_f32 v219, v219, v195
    v_add_f32 v220, 1.0, v220
    v_add_f32 v221, 1.0, v221
    v_add_f32 v222, 1.0, v222
    v_add_f32 v223, 1.0, v223
    v_add_f32 v224, 1.0, v224
    v_add_f32 v225, 1.0, v225
    v_add_f32 v226, 1.0, v226
    v_add_f32 v227, 1.0, v227
    ds_read_b64_tr_b16 v[244:245], v4 offset:30720
    ds_read_b64_tr_b16 v[246:247], v4 offset:31232
    ds_read_b64_tr_b16 v[248:249], v4 offset:31744
    ds_read_b64_tr_b16 v[250:251], v4 offset:32256
    ds_read_b64_tr_b16 v[252:253], v4 offset:32768
    ds_read_b64_tr_b16 v[254:255], v4 offset:33280
    s_setprio 1
    s_waitcnt lgkmcnt(0)
    v_cvt_pk_bf16_f32 v228, v212, v213
    v_cvt_pk_bf16_f32 v229, v214, v215
    v_cvt_pk_bf16_f32 v230, v216, v217
    v_cvt_pk_bf16_f32 v231, v218, v219
    s_nop 1
    v_mfma_f32_32x32x16_bf16 v[108:123], v[244:247], v[228:231], v[108:123]
    v_rcp_f32 v220, v220
    v_rcp_f32 v221, v221
    v_rcp_f32 v222, v222
    v_mfma_f32_32x32x16_bf16 v[124:139], v[248:251], v[228:231], v[124:139]
    v_rcp_f32 v223, v223
    v_rcp_f32 v224, v224
    v_rcp_f32_e64 v225, v225
    v_mfma_f32_32x32x16_bf16 v[140:155], v[252:255], v[228:231], v[140:155]
    v_rcp_f32 v226, v226
    v_rcp_f32 v227, v227
    s_setprio 2
    v_mul_f32 v220, v220, v196
    v_mul_f32 v221, v221, v197
    v_mul_f32 v222, v222, v198
    v_mul_f32 v223, v223, v199
    v_mul_f32 v224, v224, v200
    v_mul_f32 v225, v225, v201
    v_mul_f32 v226, v226, v202
    v_mul_f32_e64 v227, v227, v203
    ds_read_b64_tr_b16 v[244:245], v4 offset:33792
    ds_read_b64_tr_b16 v[246:247], v4 offset:34304
    ds_read_b64_tr_b16 v[248:249], v4 offset:34816
    ds_read_b64_tr_b16 v[250:251], v4 offset:35328
    ds_read_b64_tr_b16 v[252:253], v4 offset:35840
    ds_read_b64_tr_b16 v[254:255], v4 offset:36352
    s_setprio 1
    s_waitcnt lgkmcnt(0)
    v_cvt_pk_bf16_f32 v228, v220, v221
    v_cvt_pk_bf16_f32 v229, v222, v223
    v_cvt_pk_bf16_f32 v230, v224, v225
    v_cvt_pk_bf16_f32 v231, v226, v227
    s_nop 1
    v_mfma_f32_32x32x16_bf16 v[108:123], v[244:247], v[228:231], v[108:123]
    v_mfma_f32_32x32x16_bf16 v[124:139], v[248:251], v[228:231], v[124:139]
    v_mfma_f32_32x32x16_bf16 v[140:155], v[252:255], v[228:231], v[140:155]
    s_setprio 2
    s_mov_b32 s28, s29
    s_mov_b32 s10, 50331648
    s_sub_u32 s26, s26, 1
    s_cmp_lg_u32 s26, 0
    s_cbranch_scc1 L_loopB_pre
    s_waitcnt vmcnt(0) lgkmcnt(0)
    s_mul_i32 s68, s24, 6144
    s_add_u32 s69, s68, 43008
    s_cmp_ge_u32 s24, 5
    s_cselect_b32 s68, s69, s68
    v_add_u32 v1, s68, v7
    v_subrev_u32 v2, 150016, v6
    v_add_u32 v3, s68, v2
    v_add_u32 v4, 0x1000, v2
    ds_read_b128 v[156:159], v5 offset:1920
    ds_read_b128 v[160:163], v5 offset:1952
    ds_read_b128 v[164:167], v5 offset:1984
    ds_read_b128 v[168:171], v5 offset:2016
    ds_read_b128 v[172:175], v5 offset:2048
    ds_read_b128 v[176:179], v5 offset:2080
    ds_read_b128 v[180:183], v5 offset:2112
    ds_read_b128 v[184:187], v5 offset:2144
    ds_read_b128 v[188:191], v5 offset:2176
    ds_read_b128 v[192:195], v5 offset:2208
    ds_read_b128 v[196:199], v5 offset:2240
    ds_read_b128 v[200:203], v5 offset:2272
    s_waitcnt lgkmcnt(8)
    v_mfma_f32_32x32x16_bf16 v[156:171], v[12:15], v[60:63], v[156:171]
    v_mfma_f32_32x32x16_bf16 v[156:171], v[16:19], v[64:67], v[156:171]
    ds_read_b128 v[36:39], v5 offset:1536
    ds_read_b128 v[40:43], v5 offset:1568
    ds_read_b128 v[44:47], v5 offset:1600
    ds_read_b128 v[48:51], v5 offset:1632
    s_waitcnt lgkmcnt(8)
    v_mfma_f32_32x32x16_bf16 v[172:187], v[12:15], v[68:71], v[172:187]
    v_mfma_f32_32x32x16_bf16 v[172:187], v[16:19], v[72:75], v[172:187]
    ds_read_b128 v[204:207], v5 offset:1664
    ds_read_b128 v[208:211], v5 offset:1696
    ds_read_b128 v[212:215], v5 offset:1728
    ds_read_b128 v[216:219], v5 offset:1760
    s_waitcnt lgkmcnt(8)
    v_mfma_f32_32x32x16_bf16 v[188:203], v[12:15], v[76:79], v[188:203]
    v_mfma_f32_32x32x16_bf16 v[188:203], v[16:19], v[80:83], v[188:203]
    ds_read_b128 v[20:23], v5 offset:1792
    ds_read_b128 v[24:27], v5 offset:1824
    ds_read_b128 v[28:31], v5 offset:1856
    ds_read_b128 v[32:35], v5 offset:1888
    s_waitcnt lgkmcnt(11)
    v_fma_f32 v108, v108, v36, v156
    v_fma_f32 v109, v109, v37, v157
    v_fma_f32 v110, v110, v38, v158
    v_fma_f32 v111, v111, v39, v159
    s_waitcnt lgkmcnt(10)
    v_fma_f32 v112, v112, v40, v160
    v_fma_f32 v113, v113, v41, v161
    v_fma_f32 v114, v114, v42, v162
    v_fma_f32 v115, v115, v43, v163
    s_waitcnt lgkmcnt(9)
    v_fma_f32 v116, v116, v44, v164
    v_fma_f32 v117, v117, v45, v165
    v_fma_f32 v118, v118, v46, v166
    v_fma_f32 v119, v119, v47, v167
    s_waitcnt lgkmcnt(8)
    v_fma_f32 v120, v120, v48, v168
    v_fma_f32 v121, v121, v49, v169
    v_fma_f32 v122, v122, v50, v170
    v_fma_f32 v123, v123, v51, v171
    v_cvt_pk_bf16_f32 v108, v108, v109
    v_cvt_pk_bf16_f32 v109, v110, v111
    v_cvt_pk_bf16_f32 v110, v112, v113
    v_cvt_pk_bf16_f32 v111, v114, v115
    v_cvt_pk_bf16_f32 v112, v116, v117
    v_cvt_pk_bf16_f32 v113, v118, v119
    v_cvt_pk_bf16_f32 v114, v120, v121
    v_cvt_pk_bf16_f32 v115, v122, v123
    ds_write_b128 v1, v[108:111] offset:0
    ds_write_b128 v1, v[112:115] offset:32
    s_waitcnt lgkmcnt(9)
    v_fma_f32 v124, v124, v204, v172
    v_fma_f32 v125, v125, v205, v173
    v_fma_f32 v126, v126, v206, v174
    v_fma_f32 v127, v127, v207, v175
    s_waitcnt lgkmcnt(8)
    v_fma_f32 v128, v128, v208, v176
    v_fma_f32 v129, v129, v209, v177
    v_fma_f32 v130, v130, v210, v178
    v_fma_f32 v131, v131, v211, v179
    s_waitcnt lgkmcnt(7)
    v_fma_f32 v132, v132, v212, v180
    v_fma_f32 v133, v133, v213, v181
    v_fma_f32 v134, v134, v214, v182
    v_fma_f32 v135, v135, v215, v183
    s_waitcnt lgkmcnt(6)
    v_fma_f32 v136, v136, v216, v184
    v_fma_f32 v137, v137, v217, v185
    v_fma_f32 v138, v138, v218, v186
    v_fma_f32 v139, v139, v219, v187
    v_cvt_pk_bf16_f32 v124, v124, v125
    v_cvt_pk_bf16_f32 v125, v126, v127
    v_cvt_pk_bf16_f32 v126, v128, v129
    v_cvt_pk_bf16_f32 v127, v130, v131
    v_cvt_pk_bf16_f32 v128, v132, v133
    v_cvt_pk_bf16_f32 v129, v134, v135
    v_cvt_pk_bf16_f32 v130, v136, v137
    v_cvt_pk_bf16_f32 v131, v138, v139
    ds_write_b128 v1, v[124:127] offset:64
    ds_write_b128 v1, v[128:131] offset:96
    s_waitcnt lgkmcnt(7)
    v_fma_f32 v140, v140, v20, v188
    v_fma_f32 v141, v141, v21, v189
    v_fma_f32 v142, v142, v22, v190
    v_fma_f32 v143, v143, v23, v191
    s_waitcnt lgkmcnt(6)
    v_fma_f32 v144, v144, v24, v192
    v_fma_f32 v145, v145, v25, v193
    v_fma_f32 v146, v146, v26, v194
    v_fma_f32 v147, v147, v27, v195
    s_waitcnt lgkmcnt(5)
    v_fma_f32 v148, v148, v28, v196
    v_fma_f32 v149, v149, v29, v197
    v_fma_f32 v150, v150, v30, v198
    v_fma_f32 v151, v151, v31, v199
    s_waitcnt lgkmcnt(4)
    v_fma_f32 v152, v152, v32, v200
    v_fma_f32 v153, v153, v33, v201
    v_fma_f32 v154, v154, v34, v202
    v_fma_f32 v155, v155, v35, v203
    v_cvt_pk_bf16_f32 v140, v140, v141
    v_cvt_pk_bf16_f32 v141, v142, v143
    v_cvt_pk_bf16_f32 v142, v144, v145
    v_cvt_pk_bf16_f32 v143, v146, v147
    v_cvt_pk_bf16_f32 v144, v148, v149
    v_cvt_pk_bf16_f32 v145, v150, v151
    v_cvt_pk_bf16_f32 v146, v152, v153
    v_cvt_pk_bf16_f32 v147, v154, v155
    ds_write_b128 v1, v[140:143] offset:128
    ds_write_b128 v1, v[144:147] offset:160
    s_waitcnt lgkmcnt(0)
    ds_read_b128 v[84:87], v3 offset:0
    ds_read_b128 v[88:91], v3 offset:1024
    ds_read_b128 v[92:95], v3 offset:2048
    ds_read_b128 v[96:99], v3 offset:3072
    ds_read_b128 v[100:103], v3 offset:4096
    ds_read_b128 v[104:107], v3 offset:5120
    s_waitcnt lgkmcnt(5)
    buffer_store_dwordx4 v[84:87], v2, s[8:11], s28 offen offset:0 nt
    s_waitcnt lgkmcnt(4)
    buffer_store_dwordx4 v[88:91], v2, s[8:11], s28 offen offset:1024 nt
    s_waitcnt lgkmcnt(3)
    buffer_store_dwordx4 v[92:95], v2, s[8:11], s28 offen offset:2048 nt
    s_waitcnt lgkmcnt(2)
    buffer_store_dwordx4 v[96:99], v2, s[8:11], s28 offen offset:3072 nt
    s_waitcnt lgkmcnt(1)
    buffer_store_dwordx4 v[100:103], v4, s[8:11], s28 offen offset:0 nt
    s_waitcnt lgkmcnt(0)
    buffer_store_dwordx4 v[104:107], v4, s[8:11], s28 offen offset:1024 nt
    s_endpgm
L_loopB_pre:
    s_branch L_loopB
L_end:
    s_endpgm
.section .rodata,"a"
.p2align 6
.amdhsa_kernel standalone__modern_conv_block_convnext__vision_kernel
  .amdhsa_next_free_vgpr 256
  .amdhsa_next_free_sgpr 100
  .amdhsa_accum_offset 256
  .amdhsa_group_segment_fixed_size 0
  .amdhsa_kernarg_size 80
  .amdhsa_user_sgpr_count 2
  .amdhsa_user_sgpr_kernarg_segment_ptr 1
  .amdhsa_system_sgpr_workgroup_id_x 1
.end_amdhsa_kernel
```
